```python
import torch

def _softmax(x, axis=-1):
    return torch.softmax(x, dim=axis)
def _gelu(x):
    return torch.nn.functional.gelu(x, approximate="tanh")
def _silu(x):
    return torch.nn.functional.silu(x)
def _sigmoid(x):
    return torch.sigmoid(x)
def _layernorm(x, axis=-1, eps=1e-5):
    m = x.mean(dim=axis, keepdim=True)
    v = x.var(dim=axis, keepdim=True, unbiased=False)
    return (x - m) / torch.sqrt(v + eps)
def _scatter_add(tgt, idx, src, axis=0):
    return tgt.clone().index_add_(axis, idx, src)
def _segment_sum(src, seg, n):
    out = torch.zeros((n,) + src.shape[1:], dtype=src.dtype)
    return out.index_add_(0, seg, src)
def _pad(x, pw):
    flat = tuple(v for pair in reversed(pw) for v in pair)
    return torch.nn.functional.pad(x, flat)

kernel_name = 'sequential_preLN__sliding_local_dilated__glu_gated_bilinear__prompt'

def setup_inputs():

    _w = (lambda a: (lambda t: t.to(torch.bfloat16) if t.is_floating_point() else t)(torch.as_tensor(a)))
    def _A_setup():
        B, S, D = 1, 2048, 512
        return {
            "x": _w((lambda *s: torch.randn(*s, dtype=torch.bfloat16) * 0.05)(B, S, D)),
            "wqkv": _w((lambda *s: torch.randn(*s, dtype=torch.bfloat16) * 0.05)(D, 3 * D)),
            "wo": _w((lambda *s: torch.randn(*s, dtype=torch.bfloat16) * 0.05)(D, D)),
        }
    _A_in = _A_setup()

    def _B_setup():
        B, S, D, F = 1, 2048, 512, 1792
        return {
            "x": _w((lambda *s: torch.randn(*s, dtype=torch.bfloat16) * 0.05)(B, S, D)),
            "w_gate": _w((lambda *s: torch.randn(*s, dtype=torch.bfloat16) * 0.8)(D, F) * (D ** -0.5)),
            "w_up": _w((lambda *s: torch.randn(*s, dtype=torch.bfloat16) * 0.8)(D, F) * (D ** -0.5)),
            "w_down": _w((lambda *s: torch.randn(*s, dtype=torch.bfloat16) * 0.8)(F, D) * (F ** -0.5)),
        }
    _B_in = _B_setup()

    return {
        "A_x": _A_in["x"],
        "A_wqkv": _A_in["wqkv"],
        "A_wo": _A_in["wo"],
        "B_x": _B_in["x"],
        "B_w_gate": _B_in["w_gate"],
        "B_w_up": _B_in["w_up"],
        "B_w_down": _B_in["w_down"],
    }

def reference(A_x, A_wqkv, A_wo, B_x, B_w_gate, B_w_up, B_w_down):
    def _A_ref(x, wqkv, wo):
        B, S, D = x.shape
        H = 32; Dh = D // H
        W, dil = 8, 2
        qkv = (lambda x, *d: x.permute(*d))((x @ wqkv).reshape(B, S, 3, H, Dh), 2, 0, 3, 1, 4)
        q, k, v = qkv[0], qkv[1], qkv[2]
        scale = Dh ** -0.5
        pos = torch.arange(S)
        off = torch.arange(W) * dil
        idx = pos[:, None] - off[None, :]
        mask = idx >= 0
        idx_c = torch.where(mask, idx, 0).reshape(-1)
        kg = k[:, :, idx_c, :].reshape(B, H, S, W, Dh)
        vg = v[:, :, idx_c, :].reshape(B, H, S, W, Dh)
        logits = torch.einsum("bhsd,bhswd->bhsw", q, kg) * scale
        logits = torch.where(mask[None, None, :, :], logits, -1e9)
        attn = _softmax(logits, axis=-1)
        o = torch.einsum("bhsw,bhswd->bhsd", attn, vg)
        return (lambda x, *d: x.permute(*d))(o, 0, 2, 1, 3).reshape(B, S, D) @ wo

    def _B_ref(x, w_gate, w_up, w_down):
        g = torch.einsum("bsd,df->bsf", x, w_gate)
        u = torch.einsum("bsd,df->bsf", x, w_up)
        h = g * u
        return torch.einsum("bsf,fd->bsd", h, w_down)

    x = A_x
    h = x + _A_ref(_layernorm(x, axis=-1), A_wqkv, A_wo)
    h2 = h + _B_ref(_layernorm(h, axis=-1), B_w_gate, B_w_up, B_w_down)
    return h2
```

```asm
; @launch grid=(256,1,1) block=(256,1,1) lds=163840
.amdgcn_target "amdgcn-amd-amdhsa--gfx950"
.text
.globl sequential_preLN__sliding_local_dilated__glu_gated_bilinear__prompt_kernel
.p2align 8
.type sequential_preLN__sliding_local_dilated__glu_gated_bilinear__prompt_kernel,@function
sequential_preLN__sliding_local_dilated__glu_gated_bilinear__prompt_kernel:
  s_cmp_ge_u32 s2, 256
  s_cbranch_scc1 Lexit
  s_load_dwordx2 s[8:9], s[0:1], 8
  s_load_dwordx2 s[4:5], s[0:1], 0
  v_lshrrev_b32 v20, 6, v0
  s_getpc_b64 s[48:49]
  s_lshr_b32 s50, s2, 3
  v_lshl_add_u32 v23, s50, 2, v20
  v_lshlrev_b32 v23, 7, v23
  v_add_co_u32 v176, vcc, s48, v23
  v_mov_b32 v177, s49
  v_and_b32 v1, 63, v0
  v_readfirstlane_b32 s40, v20
  v_addc_co_u32 v177, vcc, 0, v177, vcc
  global_load_dword v178, v[176:177], off
  s_bfe_u32 s44, s2, 0x30003
  s_and_b32 s48, s2, 7
  s_lshr_b32 s43, s2, 6
  s_lshl2_add_u32 s43, s48, s43
  s_cmp_eq_u32 s44, 3
  s_cselect_b32 s97, 4, 0
  s_add_u32 s97, s97, s48
  s_add_u32 s3, s44, s97
  v_lshrrev_b32 v20, 3, v1
  v_and_b32 v21, 7, v1
  v_and_b32 v23, 2, v20
  v_xor_b32_e64 v23, v21, v23
  v_lshlrev_b32 v23, 4, v23
  s_movk_i32 s49, 3072
  v_mad_u32_u24 v24, v20, s49, v23
  s_mul_i32 s48, s40, 49152
  s_lshl_b32 s49, s44, 7
  s_add_u32 s48, s48, s49
  v_add_u32_e64 v24, s48, v24
  s_mul_i32 s54, s40, 6144
  s_add_u32 s54, s54, 8192
  s_mov_b32 s10, 1572864
  s_mov_b32 s11, 0x20000
  s_add_u32 s57, s3, 0
  s_and_b32 s57, s57, 7
  s_lshl_b32 s58, s57, 7
  s_add_u32 m0, s54, 0
  s_mul_i32 s57, s57, 196608
  s_waitcnt lgkmcnt(0)
  s_nop 0
  buffer_load_dwordx4 v24, s[8:11], s57 offen offset:0 lds
  buffer_load_dwordx4 v24, s[8:11], s57 offen offset:1024 lds
  buffer_load_dwordx4 v24, s[8:11], s57 offen offset:2048 lds
  v_xor_b32 v25, 64, v24
  v_add_u32 v25, 24576, v25
  s_add_u32 m0, s54, 3072
  s_nop 0
  buffer_load_dwordx4 v25, s[8:11], s57 offen offset:0 lds
  buffer_load_dwordx4 v25, s[8:11], s57 offen offset:1024 lds
  buffer_load_dwordx4 v25, s[8:11], s57 offen offset:2048 lds
  s_lshr_b32 s90, s2, 3
  s_lshl2_add_u32 s90, s90, s40
  s_lshl_b32 s90, s90, 7
Lpc:
  v_lshrrev_b32 v22, 4, v1
  s_mov_b32 s6, 2097152
  s_mov_b32 s7, 0x20000
  s_lshr_b32 s46, s40, 1
  s_and_b32 s47, s40, 1
  v_xor_b32 v23, v21, v22
  v_lshlrev_b32 v23, 4, v23
  v_lshl_add_u32 v26, v20, 11, v23
  s_lshl_b32 s48, s43, 1
  s_add_u32 s68, s48, s46
  s_lshl_b32 s48, s68, 5
  s_add_u32 s48, s48, s47
  s_lshl_b32 s48, s48, 10
  v_add_u32 v26, s48, v26
  v_xor_b32 v27, 64, v26
  v_add_u32 v27, 15360, v27
  s_lshl_b32 s55, s40, 11
  s_add_u32 m0, s55, 0
  s_nop 0
  buffer_load_dwordx4 v26, s[4:7], s58 offen lds
  buffer_load_dwordx4 v27, s[4:7], s58 offen offset:1024 lds
  s_load_dwordx2 s[32:33], s[0:1], 72
  s_load_dwordx2 s[12:13], s[0:1], 16
  s_load_dwordx4 s[20:23], s[0:1], 32
  s_load_dwordx2 s[24:25], s[0:1], 48
  s_load_dwordx2 s[28:29], s[0:1], 56
  s_lshl_b32 s49, s43, 6
  s_sub_u32 s48, s49, s47
  s_sub_u32 s48, s48, 15
  v_lshl_add_u32 v28, v20, 1, s48
  v_max_i32 v28, 0, v28
  s_lshl_b32 s50, s47, 6
  v_xor_b32 v23, s50, v23
  v_lshl_add_u32 v28, v28, 10, v23
  s_add_u32 s60, s3, s46
  s_lshl_b32 s56, s40, 10
  s_add_u32 s56, s56, 131072
  s_lshl_b32 s50, s40, 1
  s_add_u32 s63, s60, 0
  s_and_b32 s63, s63, 7
  s_lshl_b32 s63, s63, 7
  s_add_u32 m0, s56, 0
  s_mov_b32 exec_lo, 0xffffff00
  buffer_load_dwordx4 v28, s[4:7], s63 offen lds
  s_mov_b32 exec_lo, -1
  s_lshl3_add_u32 s48, s44, s49
  s_add_u32 s48, s48, s50
  v_lshrrev_b32 v23, 5, v1
  v_add_u32 v41, s48, v23
  v_and_b32 v23, 31, v1
  v_lshlrev_b32 v23, 4, v23
  v_lshl_add_u32 v42, v41, 10, v23
  buffer_load_dwordx4 v[168:171], v42, s[4:7], 0 offen
  buffer_load_dwordx4 v[172:175], v42, s[4:7], 0 offen offset:512
  v_and_b32 v23, 3, v1
  s_lshr_b32 s48, s90, 5
  v_add_u32 v23, s48, v23
  v_lshlrev_b32 v193, 10, v23
  v_lshrrev_b32_e64 v192, 2, v1
  v_mad_u32_u24 v192, v23, 3, v192
  v_lshlrev_b32_e64 v192, 10, v192
  s_mov_b64 exec, 0xfff
  buffer_load_dword v194, v192, s[8:11], 0 offen offset:384
  s_mov_b64 exec, -1
  v_lshlrev_b32 v2, 4, v1
  s_lshr_b32 s41, s43, 1
  s_bfe_u32 s42, s2, 0x40003
  s_mov_b32 s34, 16777216
  s_mov_b32 s35, 0x20000
  s_waitcnt lgkmcnt(0)
  s_load_dword s45, s[32:33], 0
  s_mov_b32 s14, 524288
  s_mov_b32 s15, 0x20000
  s_mov_b32 s18, 1835008
  s_mov_b32 s19, 0x20000
  s_mov_b32 s26, 1835008
  s_mov_b32 s27, 0x20000
  s_mov_b32 s30, 2097152
  s_mov_b32 s31, 0x20000
  s_lshl_b32 s48, s47, 13
  s_add_u32 s48, s48, 131072
  v_lshlrev_b32 v23, 10, v20
  v_lshl_add_u32 v23, v21, 4, v23
  v_add_u32_e64 v23, s48, v23
  v_mov_b32 v220, 0x3f803f80
  v_mov_b32 v221, 0x3f803f80
  v_mov_b32 v222, 0x3f803f80
  v_mov_b32 v223, 0x3f803f80
  ds_write_b128 v23, v[220:223]
  v_and_b32 v43, 15, v1
  v_lshrrev_b32 v23, 1, v43
  v_xor_b32 v23, v22, v23
  v_lshlrev_b32 v23, 4, v23
  v_lshl_add_u32 v29, v43, 7, v23
  v_xor_b32_e64 v30, 64, v29
  v_bfe_u32 v179, v1, 2, 2
  v_bfe_u32 v180, v1, 1, 1
  s_lshl_b32 s49, s40, 1
  v_add_u32 v180, s49, v180
  v_and_b32 v181, 2, v179
  v_xor_b32 v180, v180, v181
  v_and_b32 v181, 1, v22
  v_lshlrev_b32 v181, 2, v181
  v_xor_b32 v180, v180, v181
  v_lshlrev_b32 v180, 4, v180
  v_lshl_add_u32 v180, v179, 7, v180
  v_and_b32 v181, 1, v1
  v_lshl_add_u32 v180, v181, 3, v180
  s_movk_i32 s49, 3072
  v_mad_u32_u24 v31, v22, s49, v180
  v_add_u32 v31, 8192, v31
  v_add_u32 v32, 65536, v29
  v_add_u32 v33, 65536, v30
  v_add_u32 v34, 65536, v31
  v_add_u32 v35, 131072, v29
  v_add_u32 v36, 131072, v30
  v_lshrrev_b32 v179, 5, v1
  v_lshlrev_b32 v179, 1, v179
  s_lshl_b32 s48, s47, 2
  v_add_u32 v179, s48, v179
  v_lshrrev_b32 v180, 1, v43
  v_xor_b32 v179, v179, v180
  v_lshlrev_b32_e64 v179, 4, v179
  v_lshl_add_u32 v179, v43, 7, v179
  v_bfe_u32 v180, v1, 4, 1
  v_lshl_add_u32 v179, v180, 11, v179
  s_sub_u32 s97, 16, s97
  s_and_b32 s97, s97, 7
  s_and_b32 s49, s97, 3
  s_mul_i32 s49, s49, 32768
  s_lshl_b32 s48, s46, 12
  s_add_u32 s48, s48, s49
  v_add_u32 v198, s48, v179
  v_xor_b32 v199, 16, v198
  v_and_b32 v23, 1, v22
  v_lshlrev_b32 v23, 2, v23
  v_xor_b32 v23, v21, v23
  v_lshlrev_b32_e64 v23, 4, v23
  v_lshl_add_u32 v3, v20, 10, v23
  s_lshl_b32 s48, s44, 7
  v_add_u32 v3, s48, v3
  v_add_u32 v4, 7168, v3
  v_add_u32 v5, 14336, v3
  v_add_u32 v6, 21504, v3
  s_lshl_b32 s64, s40, 12
  s_mul_i32 s65, s46, 917504
  s_lshl_b32 s48, s47, 15
  s_add_u32 s65, s65, s48
  s_cmp_eq_u32 s47, 0
  s_cselect_b32 s92, s20, s22
  s_cselect_b32 s93, s21, s23
  s_cmp_eq_u32 s46, 0
  s_cselect_b32 s92, s92, s12
  s_cselect_b32 s93, s93, s13
  s_cselect_b32 s48, 28, 8
  s_cselect_b32 s50, 0, s47
  s_mul_i32 s49, s48, s2
  s_lshl_b32 s94, s48, 16
  s_mov_b32 s95, 0x20000
  s_sub_u32 s48, s48, 1
  v_min_u32_e64 v247, s48, v1
  v_add_lshl_u32 v247, v247, s49, 1
  v_add_lshl_u32 v247, v247, s50, 7
  s_cmp_eq_u32 s46, 0
  s_cselect_b32 s16, s20, s22
  s_cselect_b32 s17, s21, s23
  v_and_b32 v23, 1, v22
  v_lshlrev_b32 v23, 1, v23
  v_xor_b32 v23, v21, v23
  s_lshl_b32 s48, s46, 2
  v_xor_b32 v23, s48, v23
  v_lshlrev_b32 v23, 4, v23
  s_movk_i32 s49, 3584
  v_mad_u32_u24 v7, v20, s49, v23
  v_add_u32 v8, 27648, v7
  v_add_u32 v9, 55296, v7
  v_add_u32 v10, 82944, v7
  s_lshl_b32 s66, s40, 12
  s_cmp_gt_u32 s42, 3
  s_cselect_b32 s48, 1, 0
  s_cmp_gt_u32 s42, 11
  s_cselect_b32 s49, 1, 0
  s_add_u32 s48, s48, s49
  s_sub_u32 s48, s42, s48
  s_lshr_b32 s49, s42, 3
  s_add_u32 s49, s49, 14
  s_cmp_eq_u32 s44, 3
  s_cselect_b32 s42, s49, s48
  s_lshl_b32 s48, s41, 1
  s_add_u32 s48, s48, s42
  s_sub_u32 s69, s48, 14
  s_min_u32 s48, s69, 27
  s_lshl_b32 s49, s42, 1
  s_cmp_lt_u32 s42, 14
  s_cselect_b32 s48, s49, s48
  s_lshl_b32 s67, s48, 7
  s_mul_i32 s48, s47, 114688
  s_add_u32 s67, s67, s48
  s_and_b32 s22, s41, 0
  s_mul_i32 s48, s22, 917504
  s_sub_u32 s98, s67, s48
  s_add_u32 s67, s67, s48
  s_and_b32 s48, s43, 1
  s_lshl_b32 s49, s40, 1
  s_add_u32 s48, s48, s49
  s_lshl_b32 s100, s48, 12
  s_lshl_b32 s101, s48, 15
  s_and_b32 s48, s43, 2
  s_lshl_b32 s48, s48, 17
  s_add_u32 s101, s101, s48
  v_lshlrev_b32 v11, 2, v1
  v_lshlrev_b32 v253, 2, v43
  v_lshlrev_b32 v191, 3, v43
  v_min_u32 v254, 24, v11
  v_lshlrev_b32 v23, 2, v22
  v_sub_u32 v179, v23, v43
  v_mov_b32 v180, 0xf149f2ca
  s_cmp_eq_u32 s43, 0
  s_cselect_b32 s50, 99, 9
  s_cselect_b32 s51, 99, 1
  v_add_u32 v181, 0, v179
  s_add_u32 s57, s3, 1
  s_and_b32 s57, s57, 7
  s_lshl_b32 s58, s57, 7
  s_add_u32 m0, s54, 32768
  s_mul_i32 s57, s57, 196608
  buffer_load_dwordx4 v24, s[8:11], s57 offen offset:0 lds
  v_add_u32_e64 v182, 7, v181
  v_cmp_gt_u32 vcc, 8, v182
  s_nop 1
  v_cndmask_b32 v200, v180, 0, vcc
  v_cndmask_b32 v183, 0, -1, vcc
  v_and_b32 v216, 0xffff, v183
  v_cmp_le_i32 vcc, 9, v181
  s_nop 1
  v_cndmask_b32 v204, v180, 0, vcc
  buffer_load_dwordx4 v24, s[8:11], s57 offen offset:1024 lds
  v_cmp_le_i32 vcc, s50, v181
  s_nop 1
  v_cndmask_b32 v208, v180, 0, vcc
  v_cmp_le_i32 vcc, s51, v181
  s_nop 1
  v_cndmask_b32 v212, v180, 0, vcc
  v_cmp_lt_u32 vcc, 31, v1
  s_nop 1
  v_cndmask_b32 v212, v212, v180, vcc
  v_add_u32 v181, 1, v179
  buffer_load_dwordx4 v24, s[8:11], s57 offen offset:2048 lds
  v_add_u32_e64 v182, 7, v181
  v_cmp_gt_u32 vcc, 8, v182
  s_nop 1
  v_cndmask_b32 v201, v180, 0, vcc
  v_cndmask_b32 v183, 0, -1, vcc
  v_and_b32 v183, 0xffff0000, v183
  v_or_b32_e64 v216, v216, v183
  v_cmp_le_i32 vcc, 9, v181
  s_add_u32 m0, s54, 35840
  s_nop 0
  buffer_load_dwordx4 v25, s[8:11], s57 offen offset:0 lds
  v_cndmask_b32 v205, v180, 0, vcc
  v_cmp_le_i32 vcc, s50, v181
  s_nop 1
  v_cndmask_b32 v209, v180, 0, vcc
  v_cmp_le_i32 vcc, s51, v181
  s_nop 1
  v_cndmask_b32 v213, v180, 0, vcc
  v_cmp_lt_u32 vcc, 31, v1
  s_nop 1
  v_cndmask_b32_e64 v213, v213, v180, vcc
  buffer_load_dwordx4 v25, s[8:11], s57 offen offset:1024 lds
  v_add_u32 v181, 2, v179
  v_add_u32 v182, 7, v181
  v_cmp_gt_u32 vcc, 8, v182
  s_nop 1
  v_cndmask_b32 v202, v180, 0, vcc
  v_cndmask_b32 v183, 0, -1, vcc
  v_and_b32 v217, 0xffff, v183
  v_cmp_le_i32 vcc, 9, v181
  buffer_load_dwordx4 v25, s[8:11], s57 offen offset:2048 lds
  s_nop 0
  v_cndmask_b32 v206, v180, 0, vcc
  v_cmp_le_i32 vcc, s50, v181
  s_nop 1
  v_cndmask_b32 v210, v180, 0, vcc
  v_cmp_le_i32 vcc, s51, v181
  s_nop 1
  v_cndmask_b32 v214, v180, 0, vcc
  v_cmp_lt_u32 vcc, 31, v1
  s_nop 1
  v_cndmask_b32 v214, v214, v180, vcc
  s_add_u32 m0, s55, 32768
  s_nop 0
  buffer_load_dwordx4 v26, s[4:7], s58 offen lds
  v_add_u32 v181, 3, v179
  v_add_u32 v182, 7, v181
  v_cmp_gt_u32 vcc, 8, v182
  s_nop 1
  v_cndmask_b32 v203, v180, 0, vcc
  v_cndmask_b32 v183, 0, -1, vcc
  v_and_b32 v183, 0xffff0000, v183
  v_or_b32_e64 v217, v217, v183
  buffer_load_dwordx4 v27, s[4:7], s58 offen offset:1024 lds
  v_cmp_le_i32 vcc, 9, v181
  s_nop 1
  v_cndmask_b32 v207, v180, 0, vcc
  v_cmp_le_i32 vcc, s50, v181
  s_nop 1
  v_cndmask_b32 v211, v180, 0, vcc
  v_cmp_le_i32 vcc, s51, v181
  s_nop 1
  v_cndmask_b32 v215, v180, 0, vcc
  v_cmp_lt_u32 vcc, 31, v1
  s_waitcnt lgkmcnt(0)
  s_add_u32 s45, s45, 0x9e3779b9
  v_mov_b32_e64 v176, 0
  v_mov_b32 v177, 0
  s_waitcnt vmcnt(9)
  v_dot2c_f32_bf16 v176, v168, v220
  v_dot2c_f32_bf16 v177, v168, v168
  v_dot2c_f32_bf16 v176, v169, v220
  v_dot2c_f32_bf16 v177, v169, v169
  v_dot2c_f32_bf16 v176, v170, v220
  v_dot2c_f32_bf16 v177, v170, v170
  v_dot2c_f32_bf16 v176, v171, v220
  v_dot2c_f32_bf16 v177, v171, v171
  v_dot2c_f32_bf16 v176, v172, v220
  v_dot2c_f32_bf16 v177, v172, v172
  v_dot2c_f32_bf16 v176, v173, v220
  v_dot2c_f32_bf16 v177, v173, v173
  s_add_u32 s57, s3, 2
  s_and_b32 s57, s57, 7
  s_lshl_b32 s58, s57, 7
  s_add_u32 m0, s54, 65536
  s_mul_i32 s57, s57, 196608
  buffer_load_dwordx4 v24, s[8:11], s57 offen offset:0 lds
  v_dot2c_f32_bf16 v176, v174, v220
  v_dot2c_f32_bf16 v177, v174, v174
  v_dot2c_f32_bf16 v176, v175, v220
  v_dot2c_f32_bf16 v177, v175, v175
  s_nop 1
  v_add_f32_dpp v176, v176, v176 row_ror:8 row_mask:0xf bank_mask:0xf
  v_add_f32_dpp v177, v177, v177 row_ror:8 row_mask:0xf bank_mask:0xf
  s_nop 0
  v_add_f32_dpp v176, v176, v176 row_ror:4 row_mask:0xf bank_mask:0xf
  v_add_f32_dpp v177, v177, v177 row_ror:4 row_mask:0xf bank_mask:0xf
  s_nop 0
  v_add_f32_dpp v176, v176, v176 row_ror:2 row_mask:0xf bank_mask:0xf
  v_add_f32_dpp v177, v177, v177 row_ror:2 row_mask:0xf bank_mask:0xf
  s_nop 0
  v_add_f32_dpp v176, v176, v176 row_ror:1 row_mask:0xf bank_mask:0xf
  v_add_f32_dpp v177, v177, v177 row_ror:1 row_mask:0xf bank_mask:0xf
  s_nop 0
  v_add_f32_dpp v176, v176, v176 row_bcast:15 row_mask:0xa bank_mask:0xf
  v_add_f32_dpp v177, v177, v177 row_bcast:15 row_mask:0xa bank_mask:0xf
  buffer_load_dwordx4 v24, s[8:11], s57 offen offset:1024 lds
  v_mul_f32 v168, 0x3b000000, v176
  v_mul_f32 v177, 0x3b000000, v177
  v_fma_f32 v177, -v168, v168, v177
  v_max_f32_e64 v177, 0, v177
  v_add_f32 v177, 0x3727c5ac, v177
  v_rsq_f32 v170, v177
  v_lshlrev_b32 v41, 4, v41
  v_mov_b32 v169, s45
  v_mov_b32 v251, s45
  v_mov_b32_e64 v171, s45
  s_mov_b32 s52, 4096
  s_mov_b32 exec_lo, 0x80000000
  s_mov_b32 exec_hi, 0x80000000
  buffer_store_dwordx4 v[168:171], v41, s[32:35], s52 offen sc1
  s_mov_b64 exec, -1
  s_barrier
  ds_read_b64_tr_b16 v[144:145], v31 offset:0
  ds_read_b64_tr_b16 v[146:147], v31 offset:512
  ds_read_b128 v[104:107], v29 offset:0
  ds_read_b64_tr_b16 v[148:149], v31 offset:1024
  ds_read_b64_tr_b16 v[150:151], v31 offset:1536
  ds_read_b64_tr_b16 v[152:153], v31 offset:2048
  ds_read_b64_tr_b16 v[154:155], v31 offset:2560
  ds_read_b128 v[108:111], v29 offset:2048
  ds_read_b128 v[112:115], v29 offset:4096
  ds_read_b128 v[116:119], v29 offset:6144
  ds_read_b128 v[120:123], v35 offset:0
  s_getreg_b32 s91, hwreg(HW_REG_XCC_ID, 0, 4)
  s_cmp_lg_u32 s40, 0
  s_cbranch_scc1 Lnoxc
  s_bfe_u32 s52, s2, 0x40003
  s_lshl4_add_u32 s52, s41, s52
  s_lshl_b32 s52, s52, 3
  v_mov_b32 v174, s45
  v_mov_b32 v175, s91
  s_add_u32 s52, s52, 36864
  s_mov_b64 exec, 1
  buffer_store_dwordx2 v[174:175], off, s[32:35], s52 sc1
  s_mov_b64 exec, -1
Lnoxc:
  s_waitcnt lgkmcnt(3)
  v_mfma_f32_16x16x32_bf16 v[44:47], v[144:147], v[104:107], 0
  ds_read_b64_tr_b16 v[156:157], v31 offset:12288
  v_cndmask_b32_e64 v215, v215, v180, vcc
  v_mfma_f32_16x16x32_bf16 v[64:67], v[148:151], v[104:107], 0
  ds_read_b64_tr_b16 v[158:159], v31 offset:12800
  v_min_u32_e64 v23, 19, v1
  v_mfma_f32_16x16x32_bf16 v[84:87], v[104:107], v[152:155], 0
  ds_read_b128 v[124:127], v30 offset:0
  v_and_b32_e64 v23, 15, v23
  v_mfma_f32_16x16x32_bf16 v[48:51], v[144:147], v[108:111], 0
  ds_read_b64_tr_b16 v[160:161], v31 offset:13312
  buffer_load_dwordx4 v24, s[8:11], s57 offen offset:2048 lds
  v_lshlrev_b32 v181, 1, v23
  v_mfma_f32_16x16x32_bf16 v[68:71], v[148:151], v[108:111], 0
  ds_read_b64_tr_b16 v[162:163], v31 offset:13824
  s_lshl_b32 s48, s46, 5
  v_mfma_f32_16x16x32_bf16 v[88:91], v[108:111], v[152:155], 0
  ds_read_b64_tr_b16 v[164:165], v31 offset:14336
  s_add_u32 s48, s48, s47
  s_waitcnt lgkmcnt(6)
  v_mfma_f32_16x16x32_bf16 v[52:55], v[144:147], v[112:115], 0
  ds_read_b64_tr_b16 v[166:167], v31 offset:14848
  s_add_u32 m0, s54, 68608
  s_nop 0
  buffer_load_dwordx4 v25, s[8:11], s57 offen offset:0 lds
  s_lshl_b32 s49, s43, 6
  v_mfma_f32_16x16x32_bf16 v[72:75], v[148:151], v[112:115], 0
  ds_read_b128 v[128:131], v30 offset:2048
  s_add_u32 s48, s48, s49
  v_mfma_f32_16x16x32_bf16 v[92:95], v[112:115], v[152:155], 0
  ds_read_b128 v[132:135], v30 offset:4096
  v_add_u32 v182, s48, v181
  v_mfma_f32_16x16x32_bf16 v[56:59], v[144:147], v[116:119], 0
  ds_read_b128 v[136:139], v30 offset:6144
  buffer_load_dwordx4 v25, s[8:11], s57 offen offset:1024 lds
  s_cmp_lt_u32 s40, 2
  s_cselect_b32 s48, 15, 32
  v_mfma_f32_16x16x32_bf16 v[76:79], v[148:151], v[116:119], 0
  ds_read_b128 v[140:143], v36 offset:0
  s_sub_u32 s48, s49, s48
  v_mfma_f32_16x16x32_bf16 v[96:99], v[116:119], v[152:155], 0
  s_cmp_lg_u32 s97, 0
  s_cbranch_scc1 Lres1
  ds_read_b128 v[12:15], v198
  ds_read_b128 v[16:19], v199
Lres1:
  buffer_load_dwordx4 v25, s[8:11], s57 offen offset:2048 lds
  s_lshl_b32 s49, s40, 3
  v_mfma_f32_16x16x32_bf16 v[60:63], v[144:147], v[120:123], 0
  s_add_u32 s48, s48, s49
  v_mfma_f32_16x16x32_bf16 v[80:83], v[148:151], v[120:123], 0
  v_add_u32 v183, s48, v181
  v_mfma_f32_16x16x32_bf16 v[100:103], v[120:123], v[152:155], 0
  v_max_i32 v183, 0, v183
  s_waitcnt vmcnt(7)
  s_waitcnt lgkmcnt(0)
  s_barrier
  v_mfma_f32_16x16x32_bf16 v[44:47], v[156:159], v[124:127], v[44:47]
  ds_read_b64_tr_b16 v[144:145], v31 offset:32768
  s_add_u32 m0, s55, 65536
  s_nop 0
  buffer_load_dwordx4 v26, s[4:7], s58 offen lds
  v_cmp_gt_u32 vcc, 16, v1
  v_mfma_f32_16x16x32_bf16 v[64:67], v[160:163], v[124:127], v[64:67]
  ds_read_b64_tr_b16 v[146:147], v31 offset:33280
  s_lshl_b32 s48, s40, 4
  v_mfma_f32_16x16x32_bf16 v[84:87], v[124:127], v[164:167], v[84:87]
  ds_read_b128 v[104:107], v29 offset:32768
  s_lshl_b32 s49, s40, 2
  v_mfma_f32_16x16x32_bf16 v[48:51], v[156:159], v[128:131], v[48:51]
  ds_read_b64_tr_b16 v[148:149], v31 offset:33792
  buffer_load_dwordx4 v27, s[4:7], s58 offen offset:1024 lds
  v_cndmask_b32_e64 v184, v183, v182, vcc
  v_mfma_f32_16x16x32_bf16 v[68:71], v[160:163], v[128:131], v[68:71]
  ds_read_b64_tr_b16 v[150:151], v31 offset:34304
  v_lshlrev_b32_e64 v184, 4, v184
  v_mfma_f32_16x16x32_bf16 v[88:91], v[128:131], v[164:167], v[88:91]
  ds_read_b64_tr_b16 v[152:153], v31 offset:34816
  s_add_u32 s49, s49, 64
  v_mfma_f32_16x16x32_bf16 v[52:55], v[156:159], v[132:135], v[52:55]
  ds_read_b64_tr_b16 v[154:155], v31 offset:35328
  s_add_u32 s63, s60, 2
  s_and_b32 s63, s63, 7
  s_lshl_b32 s63, s63, 7
  s_add_u32 m0, s56, 4096
  s_mov_b32 exec_lo, 0xffffff00
  buffer_load_dwordx4 v28, s[4:7], s63 offen lds
  s_mov_b32 exec_lo, -1
  v_mov_b32 v182, s48
  v_mfma_f32_16x16x32_bf16 v[72:75], v[160:163], v[132:135], v[72:75]
  ds_read_b128 v[108:111], v29 offset:34816
  v_mov_b32_e64 v183, s49
  v_mfma_f32_16x16x32_bf16 v[92:95], v[132:135], v[164:167], v[92:95]
  ds_read_b128 v[112:115], v29 offset:36864
  v_cndmask_b32 v185, v183, v182, vcc
  v_mfma_f32_16x16x32_bf16 v[56:59], v[156:159], v[136:139], v[56:59]
  ds_read_b128 v[116:119], v29 offset:38912
  s_add_u32 s57, s3, 3
  s_and_b32 s57, s57, 7
  s_lshl_b32 s58, s57, 7
  s_add_u32 m0, s54, 98304
  s_mul_i32 s57, s57, 196608
  buffer_load_dwordx4 v24, s[8:11], s57 offen offset:0 lds
  v_add_u32_e64 v185, v185, v23
  v_mfma_f32_16x16x32_bf16 v[76:79], v[160:163], v[136:139], v[76:79]
  ds_read_b128 v[120:123], v35 offset:2048
  v_lshlrev_b32_e64 v185, 2, v185
  v_mfma_f32_16x16x32_bf16 v[96:99], v[136:139], v[164:167], v[96:99]
  v_add_u32 v185, 147456, v185
  v_mfma_f32_16x16x32_bf16 v[60:63], v[156:159], v[140:143], v[60:63]
  v_lshlrev_b32_e64 v186, 2, v43
  v_mfma_f32_16x16x32_bf16 v[80:83], v[160:163], v[140:143], v[80:83]
  buffer_load_dwordx4 v24, s[8:11], s57 offen offset:1024 lds
  v_add_u32 v186, 147456, v186
  v_mfma_f32_16x16x32_bf16 v[100:103], v[140:143], v[164:167], v[100:103]
  v_lshlrev_b32 v187, 4, v22
  s_waitcnt lgkmcnt(3)
  v_mfma_f32_16x16x32_bf16 v[44:47], v[144:147], v[104:107], v[44:47]
  ds_read_b64_tr_b16 v[156:157], v31 offset:45056
  v_add_u32 v187, 147456, v187
  v_mfma_f32_16x16x32_bf16 v[64:67], v[148:151], v[104:107], v[64:67]
  ds_read_b64_tr_b16 v[158:159], v31 offset:45568
  buffer_load_dwordx4 v24, s[8:11], s57 offen offset:2048 lds
  v_lshlrev_b32_e64 v0, 7, v1
  v_mfma_f32_16x16x32_bf16 v[84:87], v[104:107], v[152:155], v[84:87]
  ds_read_b128 v[124:127], v30 offset:32768
  s_lshl_b32 s36, s43, 6
  v_mfma_f32_16x16x32_bf16 v[48:51], v[144:147], v[108:111], v[48:51]
  ds_read_b64_tr_b16 v[160:161], v31 offset:46080
  s_lshl2_add_u32 s36, s44, s36
  v_mfma_f32_16x16x32_bf16 v[68:71], v[148:151], v[108:111], v[68:71]
  ds_read_b64_tr_b16 v[162:163], v31 offset:46592
  s_add_u32 m0, s54, 101376
  s_nop 0
  buffer_load_dwordx4 v25, s[8:11], s57 offen offset:0 lds
  s_add_u32 s36, s36, s40
  v_mfma_f32_16x16x32_bf16 v[88:91], v[108:111], v[152:155], v[88:91]
  ds_read_b64_tr_b16 v[164:165], v31 offset:47104
  s_lshl_b32 s36, s36, 10
  s_waitcnt lgkmcnt(6)
  v_mfma_f32_16x16x32_bf16 v[52:55], v[144:147], v[112:115], v[52:55]
  ds_read_b64_tr_b16 v[166:167], v31 offset:47616
  s_add_u32 s36, s36, 1048576
  v_mfma_f32_16x16x32_bf16 v[72:75], v[148:151], v[112:115], v[72:75]
  ds_read_b128 v[128:131], v30 offset:34816
  buffer_load_dwordx4 v25, s[8:11], s57 offen offset:1024 lds
  s_add_u32 s37, s36, 32768
  v_mfma_f32_16x16x32_bf16 v[92:95], v[112:115], v[152:155], v[92:95]
  ds_read_b128 v[132:135], v30 offset:36864
  s_lshl_b32 s39, s68, 4
  v_mfma_f32_16x16x32_bf16 v[56:59], v[144:147], v[116:119], v[56:59]
  ds_read_b128 v[136:139], v30 offset:38912
  s_lshl1_add_u32 s39, s44, s39
  v_mfma_f32_16x16x32_bf16 v[76:79], v[148:151], v[116:119], v[76:79]
  ds_read_b128 v[140:143], v36 offset:2048
  buffer_load_dwordx4 v25, s[8:11], s57 offen offset:2048 lds
  s_add_u32 s39, s39, s47
  v_mfma_f32_16x16x32_bf16 v[96:99], v[116:119], v[152:155], v[96:99]
  s_cmp_lg_u32 s97, 1
  s_cbranch_scc1 Lres2
  ds_read_b128 v[12:15], v198
  ds_read_b128 v[16:19], v199
Lres2:
  s_lshl_b32 s39, s39, 11
  v_mfma_f32_16x16x32_bf16 v[60:63], v[144:147], v[120:123], v[60:63]
  s_sub_u32 s48, s37, 1024
  v_mfma_f32_16x16x32_bf16 v[80:83], v[148:151], v[120:123], v[80:83]
  s_add_u32 m0, s55, 98304
  s_nop 0
  buffer_load_dwordx4 v26, s[4:7], s58 offen lds
  v_mov_b32 v249, s36
  v_mfma_f32_16x16x32_bf16 v[100:103], v[120:123], v[152:155], v[100:103]
  v_mov_b32 v23, s48
  s_waitcnt vmcnt(7)
  s_waitcnt lgkmcnt(0)
  s_barrier
  v_mfma_f32_16x16x32_bf16 v[44:47], v[156:159], v[124:127], v[44:47]
  ds_read_b64_tr_b16 v[144:145], v34 offset:0
  v_cmp_lt_u32_e64 vcc, 7, v1
  v_mfma_f32_16x16x32_bf16 v[64:67], v[160:163], v[124:127], v[64:67]
  ds_read_b64_tr_b16 v[146:147], v34 offset:512
  buffer_load_dwordx4 v27, s[4:7], s58 offen offset:1024 lds
  s_add_u32 s48, s39, 3143680
  v_mfma_f32_16x16x32_bf16 v[84:87], v[124:127], v[164:167], v[84:87]
  ds_read_b128 v[104:107], v32 offset:0
  v_cndmask_b32_e64 v249, v249, v23, vcc
  v_mfma_f32_16x16x32_bf16 v[48:51], v[156:159], v[128:131], v[48:51]
  ds_read_b64_tr_b16 v[148:149], v34 offset:1024
  v_mov_b32_e64 v23, s48
  v_mfma_f32_16x16x32_bf16 v[68:71], v[160:163], v[128:131], v[68:71]
  ds_read_b64_tr_b16 v[150:151], v34 offset:1536
  s_add_u32 s57, s3, 4
  s_and_b32 s57, s57, 7
  s_lshl_b32 s58, s57, 7
  s_add_u32 m0, s54, 0
  s_mul_i32 s57, s57, 196608
  buffer_load_dwordx4 v24, s[8:11], s57 offen offset:0 lds
  v_cmp_lt_u32 vcc, 15, v1
  v_mfma_f32_16x16x32_bf16 v[88:91], v[128:131], v[164:167], v[88:91]
  ds_read_b64_tr_b16 v[152:153], v34 offset:2048
  s_lshr_b32 s48, s39, 3
  v_mfma_f32_16x16x32_bf16 v[52:55], v[156:159], v[132:135], v[52:55]
  ds_read_b64_tr_b16 v[154:155], v34 offset:2560
  s_add_u32 s48, s48, 258048
  v_mfma_f32_16x16x32_bf16 v[72:75], v[160:163], v[132:135], v[72:75]
  ds_read_b128 v[108:111], v32 offset:2048
  buffer_load_dwordx4 v24, s[8:11], s57 offen offset:1024 lds
  v_cndmask_b32_e64 v249, v249, v23, vcc
  v_mfma_f32_16x16x32_bf16 v[92:95], v[132:135], v[164:167], v[92:95]
  ds_read_b128 v[112:115], v32 offset:4096
  v_mov_b32_e64 v23, s48
  v_mfma_f32_16x16x32_bf16 v[56:59], v[156:159], v[136:139], v[56:59]
  ds_read_b128 v[116:119], v32 offset:6144
  v_cmp_lt_u32_e64 vcc, 31, v1
  v_mfma_f32_16x16x32_bf16 v[76:79], v[160:163], v[136:139], v[76:79]
  ds_read_b128 v[120:123], v35 offset:4096
  buffer_load_dwordx4 v24, s[8:11], s57 offen offset:2048 lds
  s_lshl_b32 s48, s43, 8
  v_mfma_f32_16x16x32_bf16 v[96:99], v[136:139], v[164:167], v[96:99]
  s_lshl_b32 s49, s47, 7
  v_mfma_f32_16x16x32_bf16 v[60:63], v[156:159], v[140:143], v[60:63]
  v_cndmask_b32_e64 v249, v249, v23, vcc
  v_mfma_f32_16x16x32_bf16 v[80:83], v[160:163], v[140:143], v[80:83]
  v_add_u32_e64 v249, v249, v0
  v_mfma_f32_16x16x32_bf16 v[100:103], v[140:143], v[164:167], v[100:103]
  s_add_u32 m0, s54, 3072
  s_nop 0
  buffer_load_dwordx4 v25, s[8:11], s57 offen offset:0 lds
  s_add_u32 s48, s48, s49
  s_waitcnt lgkmcnt(3)
  v_mfma_f32_16x16x32_bf16 v[44:47], v[144:147], v[104:107], v[44:47]
  ds_read_b64_tr_b16 v[156:157], v34 offset:12288
  s_add_u32 s48, s48, 65536
  v_mfma_f32_16x16x32_bf16 v[64:67], v[148:151], v[104:107], v[64:67]
  ds_read_b64_tr_b16 v[158:159], v34 offset:12800
  v_writelane_b32 v249, s48, 34
  v_mfma_f32_16x16x32_bf16 v[84:87], v[104:107], v[152:155], v[84:87]
  ds_read_b128 v[124:127], v33 offset:0
  buffer_load_dwordx4 v25, s[8:11], s57 offen offset:1024 lds
  s_lshl2_add_u32 s48, s41, s40
  v_mfma_f32_16x16x32_bf16 v[48:51], v[144:147], v[108:111], v[48:51]
  ds_read_b64_tr_b16 v[160:161], v34 offset:13312
  s_lshl_b32 s48, s48, 7
  v_mfma_f32_16x16x32_bf16 v[68:71], v[148:151], v[108:111], v[68:71]
  ds_read_b64_tr_b16 v[162:163], v34 offset:13824
  s_add_u32 s48, s48, 73728
  v_mfma_f32_16x16x32_bf16 v[88:91], v[108:111], v[152:155], v[88:91]
  ds_read_b64_tr_b16 v[164:165], v34 offset:14336
  buffer_load_dwordx4 v25, s[8:11], s57 offen offset:2048 lds
  v_writelane_b32 v249, s48, 35
  s_waitcnt lgkmcnt(6)
  v_mfma_f32_16x16x32_bf16 v[52:55], v[144:147], v[112:115], v[52:55]
  ds_read_b64_tr_b16 v[166:167], v34 offset:14848
  s_lshl_b32 s48, s41, 10
  v_mfma_f32_16x16x32_bf16 v[72:75], v[148:151], v[112:115], v[72:75]
  ds_read_b128 v[128:131], v33 offset:2048
  s_and_b32 s49, s68, 3
  v_mfma_f32_16x16x32_bf16 v[92:95], v[112:115], v[152:155], v[92:95]
  ds_read_b128 v[132:135], v33 offset:4096
  s_add_u32 m0, s55, 0
  s_nop 0
  buffer_load_dwordx4 v26, s[4:7], s58 offen lds
  s_lshl_b32 s49, s49, 7
  v_mfma_f32_16x16x32_bf16 v[56:59], v[144:147], v[116:119], v[56:59]
  ds_read_b128 v[136:139], v33 offset:6144
  s_add_u32 s48, s48, s49
  v_mfma_f32_16x16x32_bf16 v[76:79], v[148:151], v[116:119], v[76:79]
  ds_read_b128 v[140:143], v36 offset:4096
  s_add_u32 s48, s48, 81920
  v_mfma_f32_16x16x32_bf16 v[96:99], v[116:119], v[152:155], v[96:99]
  s_cmp_lg_u32 s97, 2
  s_cbranch_scc1 Lres3
  ds_read_b128 v[12:15], v198
  ds_read_b128 v[16:19], v199
Lres3:
  buffer_load_dwordx4 v27, s[4:7], s58 offen offset:1024 lds
  v_writelane_b32 v249, s48, 36
  v_mfma_f32_16x16x32_bf16 v[60:63], v[144:147], v[120:123], v[60:63]
  s_add_u32 s48, s48, 512
  v_mfma_f32_16x16x32_bf16 v[80:83], v[148:151], v[120:123], v[80:83]
  v_writelane_b32 v249, s48, 37
  v_mfma_f32_16x16x32_bf16 v[100:103], v[120:123], v[152:155], v[100:103]
  s_waitcnt vmcnt(8)
  s_waitcnt lgkmcnt(0)
  s_barrier
  v_mfma_f32_16x16x32_bf16 v[44:47], v[156:159], v[124:127], v[44:47]
  ds_read_b64_tr_b16 v[144:145], v34 offset:32768
  s_add_u32 s63, s60, 4
  s_and_b32 s63, s63, 7
  s_lshl_b32 s63, s63, 7
  s_add_u32 m0, s56, 8192
  s_mov_b32 exec_lo, 0xffffff00
  buffer_load_dwordx4 v28, s[4:7], s63 offen lds
  s_mov_b32 exec_lo, -1
  v_mfma_f32_16x16x32_bf16 v[64:67], v[160:163], v[124:127], v[64:67]
  ds_read_b64_tr_b16 v[146:147], v34 offset:33280
  v_mfma_f32_16x16x32_bf16 v[84:87], v[124:127], v[164:167], v[84:87]
  ds_read_b128 v[104:107], v32 offset:32768
  v_mfma_f32_16x16x32_bf16 v[48:51], v[156:159], v[128:131], v[48:51]
  ds_read_b64_tr_b16 v[148:149], v34 offset:33792
  s_mov_b64 exec, 15
  buffer_load_dword v194, v193, s[12:15], 0 offen offset:384
  s_mov_b64 exec, -1
  v_mfma_f32_16x16x32_bf16 v[68:71], v[160:163], v[128:131], v[68:71]
  ds_read_b64_tr_b16 v[150:151], v34 offset:34304
  s_add_u32 s57, s3, 5
  s_and_b32 s57, s57, 7
  s_lshl_b32 s58, s57, 7
  s_add_u32 m0, s54, 32768
  s_mul_i32 s57, s57, 196608
  buffer_load_dwordx4 v24, s[8:11], s57 offen offset:0 lds
  v_mfma_f32_16x16x32_bf16 v[88:91], v[128:131], v[164:167], v[88:91]
  ds_read_b64_tr_b16 v[152:153], v34 offset:34816
  v_mfma_f32_16x16x32_bf16 v[52:55], v[156:159], v[132:135], v[52:55]
  ds_read_b64_tr_b16 v[154:155], v34 offset:35328
  v_mfma_f32_16x16x32_bf16 v[72:75], v[160:163], v[132:135], v[72:75]
  ds_read_b128 v[108:111], v32 offset:34816
  v_mfma_f32_16x16x32_bf16 v[92:95], v[132:135], v[164:167], v[92:95]
  ds_read_b128 v[112:115], v32 offset:36864
  buffer_load_dwordx4 v24, s[8:11], s57 offen offset:1024 lds
  v_mfma_f32_16x16x32_bf16 v[56:59], v[156:159], v[136:139], v[56:59]
  ds_read_b128 v[116:119], v32 offset:38912
  v_mfma_f32_16x16x32_bf16 v[76:79], v[160:163], v[136:139], v[76:79]
  ds_read_b128 v[120:123], v35 offset:6144
  v_mfma_f32_16x16x32_bf16 v[96:99], v[136:139], v[164:167], v[96:99]
  v_mfma_f32_16x16x32_bf16 v[60:63], v[156:159], v[140:143], v[60:63]
  buffer_load_dwordx4 v24, s[8:11], s57 offen offset:2048 lds
  v_mfma_f32_16x16x32_bf16 v[80:83], v[160:163], v[140:143], v[80:83]
  v_mfma_f32_16x16x32_bf16 v[100:103], v[140:143], v[164:167], v[100:103]
  s_waitcnt lgkmcnt(3)
  v_mfma_f32_16x16x32_bf16 v[44:47], v[144:147], v[104:107], v[44:47]
  ds_read_b64_tr_b16 v[156:157], v34 offset:45056
  s_add_u32 m0, s54, 35840
  s_nop 0
  buffer_load_dwordx4 v25, s[8:11], s57 offen offset:0 lds
  v_mfma_f32_16x16x32_bf16 v[64:67], v[148:151], v[104:107], v[64:67]
  ds_read_b64_tr_b16 v[158:159], v34 offset:45568
  v_mfma_f32_16x16x32_bf16 v[84:87], v[104:107], v[152:155], v[84:87]
  ds_read_b128 v[124:127], v33 offset:32768
  v_mfma_f32_16x16x32_bf16 v[48:51], v[144:147], v[108:111], v[48:51]
  ds_read_b64_tr_b16 v[160:161], v34 offset:46080
  v_mfma_f32_16x16x32_bf16 v[68:71], v[148:151], v[108:111], v[68:71]
  ds_read_b64_tr_b16 v[162:163], v34 offset:46592
  buffer_load_dwordx4 v25, s[8:11], s57 offen offset:1024 lds
  v_mfma_f32_16x16x32_bf16 v[88:91], v[108:111], v[152:155], v[88:91]
  ds_read_b64_tr_b16 v[164:165], v34 offset:47104
  s_waitcnt lgkmcnt(6)
  v_mfma_f32_16x16x32_bf16 v[52:55], v[144:147], v[112:115], v[52:55]
  ds_read_b64_tr_b16 v[166:167], v34 offset:47616
  v_mfma_f32_16x16x32_bf16 v[72:75], v[148:151], v[112:115], v[72:75]
  ds_read_b128 v[128:131], v33 offset:34816
  v_mfma_f32_16x16x32_bf16 v[92:95], v[112:115], v[152:155], v[92:95]
  ds_read_b128 v[132:135], v33 offset:36864
  buffer_load_dwordx4 v25, s[8:11], s57 offen offset:2048 lds
  v_mfma_f32_16x16x32_bf16 v[56:59], v[144:147], v[116:119], v[56:59]
  ds_read_b128 v[136:139], v33 offset:38912
  v_mfma_f32_16x16x32_bf16 v[76:79], v[148:151], v[116:119], v[76:79]
  ds_read_b128 v[140:143], v36 offset:6144
  v_mfma_f32_16x16x32_bf16 v[96:99], v[116:119], v[152:155], v[96:99]
  s_cmp_lg_u32 s97, 3
  s_cbranch_scc1 Lres4
  ds_read_b128 v[12:15], v198
  ds_read_b128 v[16:19], v199
Lres4:
  s_add_u32 m0, s55, 32768
  s_nop 0
  buffer_load_dwordx4 v26, s[4:7], s58 offen lds
  v_mfma_f32_16x16x32_bf16 v[60:63], v[144:147], v[120:123], v[60:63]
  v_mfma_f32_16x16x32_bf16 v[80:83], v[148:151], v[120:123], v[80:83]
  v_mfma_f32_16x16x32_bf16 v[100:103], v[120:123], v[152:155], v[100:103]
  s_waitcnt vmcnt(8)
  s_waitcnt lgkmcnt(0)
  s_barrier
  s_mov_b32 s52, 4096
  buffer_load_dwordx4 v[168:171], v184, s[32:35], s52 offen sc1
  s_lshl_b32 s52, s41, 7
  s_add_u32 s52, s52, 36864
  buffer_load_dwordx2 v[172:173], v191, s[32:35], s52 offen sc1
  v_mfma_f32_16x16x32_bf16 v[44:47], v[156:159], v[124:127], v[44:47]
  ds_read_b64_tr_b16 v[144:145], v31 offset:0
  v_mfma_f32_16x16x32_bf16 v[64:67], v[160:163], v[124:127], v[64:67]
  ds_read_b64_tr_b16 v[146:147], v31 offset:512
  v_mfma_f32_16x16x32_bf16 v[84:87], v[124:127], v[164:167], v[84:87]
  ds_read_b128 v[104:107], v29 offset:0
  buffer_load_dwordx4 v27, s[4:7], s58 offen offset:1024 lds
  v_mfma_f32_16x16x32_bf16 v[48:51], v[156:159], v[128:131], v[48:51]
  ds_read_b64_tr_b16 v[148:149], v31 offset:1024
  v_mfma_f32_16x16x32_bf16 v[68:71], v[160:163], v[128:131], v[68:71]
  ds_read_b64_tr_b16 v[150:151], v31 offset:1536
  v_mfma_f32_16x16x32_bf16 v[88:91], v[128:131], v[164:167], v[88:91]
  ds_read_b64_tr_b16 v[152:153], v31 offset:2048
  v_mfma_f32_16x16x32_bf16 v[52:55], v[156:159], v[132:135], v[52:55]
  ds_read_b64_tr_b16 v[154:155], v31 offset:2560
  buffer_load_dword v248, v247, s[92:95], 0 offen offset:0
  v_mfma_f32_16x16x32_bf16 v[72:75], v[160:163], v[132:135], v[72:75]
  ds_read_b128 v[108:111], v29 offset:2048
  s_add_u32 s57, s3, 6
  s_and_b32 s57, s57, 7
  s_lshl_b32 s58, s57, 7
  s_add_u32 m0, s54, 65536
  s_mul_i32 s57, s57, 196608
  buffer_load_dwordx4 v24, s[8:11], s57 offen offset:0 lds
  v_mfma_f32_16x16x32_bf16 v[92:95], v[132:135], v[164:167], v[92:95]
  ds_read_b128 v[112:115], v29 offset:4096
  v_mfma_f32_16x16x32_bf16 v[56:59], v[156:159], v[136:139], v[56:59]
  ds_read_b128 v[116:119], v29 offset:6144
  v_mfma_f32_16x16x32_bf16 v[76:79], v[160:163], v[136:139], v[76:79]
  ds_read_b128 v[120:123], v35 offset:8192
  v_mfma_f32_16x16x32_bf16 v[96:99], v[136:139], v[164:167], v[96:99]
  buffer_load_dwordx4 v24, s[8:11], s57 offen offset:1024 lds
  v_mfma_f32_16x16x32_bf16 v[60:63], v[156:159], v[140:143], v[60:63]
  v_mfma_f32_16x16x32_bf16 v[80:83], v[160:163], v[140:143], v[80:83]
  v_mfma_f32_16x16x32_bf16 v[100:103], v[140:143], v[164:167], v[100:103]
  s_waitcnt lgkmcnt(3)
  v_mfma_f32_16x16x32_bf16 v[44:47], v[144:147], v[104:107], v[44:47]
  ds_read_b64_tr_b16 v[156:157], v31 offset:12288
  buffer_load_dwordx4 v24, s[8:11], s57 offen offset:2048 lds
  v_mfma_f32_16x16x32_bf16 v[64:67], v[148:151], v[104:107], v[64:67]
  ds_read_b64_tr_b16 v[158:159], v31 offset:12800
  v_mfma_f32_16x16x32_bf16 v[84:87], v[104:107], v[152:155], v[84:87]
  ds_read_b128 v[124:127], v30 offset:0
  v_mfma_f32_16x16x32_bf16 v[48:51], v[144:147], v[108:111], v[48:51]
  ds_read_b64_tr_b16 v[160:161], v31 offset:13312
  v_mfma_f32_16x16x32_bf16 v[68:71], v[148:151], v[108:111], v[68:71]
  ds_read_b64_tr_b16 v[162:163], v31 offset:13824
  s_add_u32 m0, s54, 68608
  s_nop 0
  buffer_load_dwordx4 v25, s[8:11], s57 offen offset:0 lds
  v_mfma_f32_16x16x32_bf16 v[88:91], v[108:111], v[152:155], v[88:91]
  ds_read_b64_tr_b16 v[164:165], v31 offset:14336
  s_waitcnt lgkmcnt(6)
  v_mfma_f32_16x16x32_bf16 v[52:55], v[144:147], v[112:115], v[52:55]
  ds_read_b64_tr_b16 v[166:167], v31 offset:14848
  v_mfma_f32_16x16x32_bf16 v[72:75], v[148:151], v[112:115], v[72:75]
  ds_read_b128 v[128:131], v30 offset:2048
  v_mfma_f32_16x16x32_bf16 v[92:95], v[112:115], v[152:155], v[92:95]
  ds_read_b128 v[132:135], v30 offset:4096
  buffer_load_dwordx4 v25, s[8:11], s57 offen offset:1024 lds
  v_mfma_f32_16x16x32_bf16 v[56:59], v[144:147], v[116:119], v[56:59]
  ds_read_b128 v[136:139], v30 offset:6144
  v_mfma_f32_16x16x32_bf16 v[76:79], v[148:151], v[116:119], v[76:79]
  ds_read_b128 v[140:143], v36 offset:8192
  v_mfma_f32_16x16x32_bf16 v[96:99], v[116:119], v[152:155], v[96:99]
  s_cmp_lg_u32 s97, 4
  s_cbranch_scc1 Lres5
  ds_read_b128 v[12:15], v198
  ds_read_b128 v[16:19], v199
Lres5:
  buffer_load_dwordx4 v25, s[8:11], s57 offen offset:2048 lds
  v_mfma_f32_16x16x32_bf16 v[60:63], v[144:147], v[120:123], v[60:63]
  v_mfma_f32_16x16x32_bf16 v[80:83], v[148:151], v[120:123], v[80:83]
  v_mfma_f32_16x16x32_bf16 v[100:103], v[120:123], v[152:155], v[100:103]
  s_waitcnt vmcnt(7)
  s_waitcnt lgkmcnt(0)
  s_barrier
  v_mfma_f32_16x16x32_bf16 v[44:47], v[156:159], v[124:127], v[44:47]
  ds_read_b64_tr_b16 v[144:145], v31 offset:32768
  s_add_u32 m0, s55, 65536
  s_nop 0
  buffer_load_dwordx4 v26, s[4:7], s58 offen lds
  v_mfma_f32_16x16x32_bf16 v[64:67], v[160:163], v[124:127], v[64:67]
  ds_read_b64_tr_b16 v[146:147], v31 offset:33280
  v_mfma_f32_16x16x32_bf16 v[84:87], v[124:127], v[164:167], v[84:87]
  ds_read_b128 v[104:107], v29 offset:32768
  v_mfma_f32_16x16x32_bf16 v[48:51], v[156:159], v[128:131], v[48:51]
  ds_read_b64_tr_b16 v[148:149], v31 offset:33792
  v_mfma_f32_16x16x32_bf16 v[68:71], v[160:163], v[128:131], v[68:71]
  ds_read_b64_tr_b16 v[150:151], v31 offset:34304
  buffer_load_dwordx4 v27, s[4:7], s58 offen offset:1024 lds
  v_mfma_f32_16x16x32_bf16 v[88:91], v[128:131], v[164:167], v[88:91]
  ds_read_b64_tr_b16 v[152:153], v31 offset:34816
  v_mfma_f32_16x16x32_bf16 v[52:55], v[156:159], v[132:135], v[52:55]
  ds_read_b64_tr_b16 v[154:155], v31 offset:35328
  v_mfma_f32_16x16x32_bf16 v[72:75], v[160:163], v[132:135], v[72:75]
  ds_read_b128 v[108:111], v29 offset:34816
  v_mfma_f32_16x16x32_bf16 v[92:95], v[132:135], v[164:167], v[92:95]
  ds_read_b128 v[112:115], v29 offset:36864
  s_add_u32 s63, s60, 6
  s_and_b32 s63, s63, 7
  s_lshl_b32 s63, s63, 7
  s_add_u32 m0, s56, 12288
  s_mov_b32 exec_lo, 0xffffff00
  buffer_load_dwordx4 v28, s[4:7], s63 offen lds
  s_mov_b32 exec_lo, -1
  v_mfma_f32_16x16x32_bf16 v[56:59], v[156:159], v[136:139], v[56:59]
  ds_read_b128 v[116:119], v29 offset:38912
  v_mfma_f32_16x16x32_bf16 v[76:79], v[160:163], v[136:139], v[76:79]
  ds_read_b128 v[120:123], v35 offset:10240
  v_mfma_f32_16x16x32_bf16 v[96:99], v[136:139], v[164:167], v[96:99]
  v_mfma_f32_16x16x32_bf16 v[60:63], v[156:159], v[140:143], v[60:63]
  s_add_u32 s57, s3, 7
  s_and_b32 s57, s57, 7
  s_lshl_b32 s58, s57, 7
  s_add_u32 m0, s54, 98304
  s_mul_i32 s57, s57, 196608
  buffer_load_dwordx4 v24, s[8:11], s57 offen offset:0 lds
  v_mfma_f32_16x16x32_bf16 v[80:83], v[160:163], v[140:143], v[80:83]
  v_mfma_f32_16x16x32_bf16 v[100:103], v[140:143], v[164:167], v[100:103]
  s_waitcnt lgkmcnt(3)
  v_mfma_f32_16x16x32_bf16 v[44:47], v[144:147], v[104:107], v[44:47]
  ds_read_b64_tr_b16 v[156:157], v31 offset:45056
  v_mfma_f32_16x16x32_bf16 v[64:67], v[148:151], v[104:107], v[64:67]
  ds_read_b64_tr_b16 v[158:159], v31 offset:45568
  buffer_load_dwordx4 v24, s[8:11], s57 offen offset:1024 lds
  v_mfma_f32_16x16x32_bf16 v[84:87], v[104:107], v[152:155], v[84:87]
  ds_read_b128 v[124:127], v30 offset:32768
  v_mfma_f32_16x16x32_bf16 v[48:51], v[144:147], v[108:111], v[48:51]
  ds_read_b64_tr_b16 v[160:161], v31 offset:46080
  v_mfma_f32_16x16x32_bf16 v[68:71], v[148:151], v[108:111], v[68:71]
  ds_read_b64_tr_b16 v[162:163], v31 offset:46592
  v_mfma_f32_16x16x32_bf16 v[88:91], v[108:111], v[152:155], v[88:91]
  ds_read_b64_tr_b16 v[164:165], v31 offset:47104
  buffer_load_dwordx4 v24, s[8:11], s57 offen offset:2048 lds
  s_waitcnt lgkmcnt(6)
  v_mfma_f32_16x16x32_bf16 v[52:55], v[144:147], v[112:115], v[52:55]
  ds_read_b64_tr_b16 v[166:167], v31 offset:47616
  v_mfma_f32_16x16x32_bf16 v[72:75], v[148:151], v[112:115], v[72:75]
  ds_read_b128 v[128:131], v30 offset:34816
  v_mfma_f32_16x16x32_bf16 v[92:95], v[112:115], v[152:155], v[92:95]
  ds_read_b128 v[132:135], v30 offset:36864
  v_mfma_f32_16x16x32_bf16 v[56:59], v[144:147], v[116:119], v[56:59]
  ds_read_b128 v[136:139], v30 offset:38912
  s_add_u32 m0, s54, 101376
  s_nop 0
  buffer_load_dwordx4 v25, s[8:11], s57 offen offset:0 lds
  v_mfma_f32_16x16x32_bf16 v[76:79], v[148:151], v[116:119], v[76:79]
  ds_read_b128 v[140:143], v36 offset:10240
  v_mfma_f32_16x16x32_bf16 v[96:99], v[116:119], v[152:155], v[96:99]
  s_cmp_lg_u32 s97, 5
  s_cbranch_scc1 Lres6
  ds_read_b128 v[12:15], v198
  ds_read_b128 v[16:19], v199
Lres6:
  v_mfma_f32_16x16x32_bf16 v[60:63], v[144:147], v[120:123], v[60:63]
  s_mov_b32 s59, 0
  v_xor_b32 v169, s45, v169
  v_xor_b32 v171, s45, v171
  v_xor_b32 v172, s45, v172
  v_or3_b32 v169, v169, v171, v172
  v_cmp_ne_u32 vcc, 0, v169
  s_nop 0
  s_cbranch_vccnz Lsp7
Lspd8:
  v_cmp_ne_u32 vcc, s91, v173
  ds_write2_b32 v185, v168, v170 offset0:0 offset1:80
  s_cmp_eq_u64 vcc, 0
  s_cselect_b32 s96, 1, 0
  buffer_load_dwordx4 v25, s[8:11], s57 offen offset:1024 lds
  v_mfma_f32_16x16x32_bf16 v[80:83], v[148:151], v[120:123], v[80:83]
  v_mfma_f32_16x16x32_bf16 v[100:103], v[120:123], v[152:155], v[100:103]
  s_waitcnt vmcnt(5)
  s_waitcnt lgkmcnt(0)
  s_barrier
  v_mfma_f32_16x16x32_bf16 v[44:47], v[156:159], v[124:127], v[44:47]
  ds_read_b64_tr_b16 v[144:145], v34 offset:0
  v_mfma_f32_16x16x32_bf16 v[64:67], v[160:163], v[124:127], v[64:67]
  ds_read_b64_tr_b16 v[146:147], v34 offset:512
  buffer_load_dwordx4 v25, s[8:11], s57 offen offset:2048 lds
  v_mfma_f32_16x16x32_bf16 v[84:87], v[124:127], v[164:167], v[84:87]
  ds_read_b128 v[104:107], v32 offset:0
  v_mfma_f32_16x16x32_bf16 v[48:51], v[156:159], v[128:131], v[48:51]
  ds_read_b64_tr_b16 v[148:149], v34 offset:1024
  v_mfma_f32_16x16x32_bf16 v[68:71], v[160:163], v[128:131], v[68:71]
  ds_read_b64_tr_b16 v[150:151], v34 offset:1536
  v_mfma_f32_16x16x32_bf16 v[88:91], v[128:131], v[164:167], v[88:91]
  ds_read_b64_tr_b16 v[152:153], v34 offset:2048
  s_add_u32 m0, s55, 98304
  s_nop 0
  buffer_load_dwordx4 v26, s[4:7], s58 offen lds
  v_mfma_f32_16x16x32_bf16 v[52:55], v[156:159], v[132:135], v[52:55]
  ds_read_b64_tr_b16 v[154:155], v34 offset:2560
  v_mfma_f32_16x16x32_bf16 v[72:75], v[160:163], v[132:135], v[72:75]
  ds_read_b128 v[108:111], v32 offset:2048
  v_mfma_f32_16x16x32_bf16 v[92:95], v[132:135], v[164:167], v[92:95]
  ds_read_b128 v[112:115], v32 offset:4096
  v_mfma_f32_16x16x32_bf16 v[56:59], v[156:159], v[136:139], v[56:59]
  ds_read_b128 v[116:119], v32 offset:6144
  buffer_load_dwordx4 v27, s[4:7], s58 offen offset:1024 lds
  v_mfma_f32_16x16x32_bf16 v[76:79], v[160:163], v[136:139], v[76:79]
  ds_read_b128 v[120:123], v35 offset:12288
  v_mfma_f32_16x16x32_bf16 v[96:99], v[136:139], v[164:167], v[96:99]
  v_mfma_f32_16x16x32_bf16 v[60:63], v[156:159], v[140:143], v[60:63]
  v_mfma_f32_16x16x32_bf16 v[80:83], v[160:163], v[140:143], v[80:83]
  buffer_load_dword v248, v247, s[92:95], 0 offen offset:128
  v_mfma_f32_16x16x32_bf16 v[100:103], v[140:143], v[164:167], v[100:103]
  s_mov_b32 exec_lo, 0xffff
  s_mov_b32 exec_hi, 0x3c
  buffer_load_dword v250, v249, s[32:35], 0 offen
  s_mov_b64 exec, -1
  s_waitcnt lgkmcnt(3)
  v_mfma_f32_16x16x32_bf16 v[44:47], v[144:147], v[104:107], v[44:47]
  ds_read_b64_tr_b16 v[156:157], v34 offset:12288
  s_xor_b32 s62, s100, 0
  s_add_u32 m0, s62, 0
  s_xor_b32 s62, s101, 0
  buffer_load_dwordx4 v3, s[12:15], s62 offen offset:0 lds
  v_mfma_f32_16x16x32_bf16 v[64:67], v[148:151], v[104:107], v[64:67]
  ds_read_b64_tr_b16 v[158:159], v34 offset:12800
  v_mfma_f32_16x16x32_bf16 v[84:87], v[104:107], v[152:155], v[84:87]
  ds_read_b128 v[124:127], v33 offset:0
  v_mfma_f32_16x16x32_bf16 v[48:51], v[144:147], v[108:111], v[48:51]
  ds_read_b64_tr_b16 v[160:161], v34 offset:13312
  v_mfma_f32_16x16x32_bf16 v[68:71], v[148:151], v[108:111], v[68:71]
  ds_read_b64_tr_b16 v[162:163], v34 offset:13824
  buffer_load_dwordx4 v4, s[12:15], s62 offen offset:1024 lds
  v_mfma_f32_16x16x32_bf16 v[88:91], v[108:111], v[152:155], v[88:91]
  ds_read_b64_tr_b16 v[164:165], v34 offset:14336
  s_waitcnt lgkmcnt(6)
  v_mfma_f32_16x16x32_bf16 v[52:55], v[144:147], v[112:115], v[52:55]
  ds_read_b64_tr_b16 v[166:167], v34 offset:14848
  v_mfma_f32_16x16x32_bf16 v[72:75], v[148:151], v[112:115], v[72:75]
  ds_read_b128 v[128:131], v33 offset:2048
  v_mfma_f32_16x16x32_bf16 v[92:95], v[112:115], v[152:155], v[92:95]
  ds_read_b128 v[132:135], v33 offset:4096
  buffer_load_dwordx4 v5, s[12:15], s62 offen offset:2048 lds
  v_mfma_f32_16x16x32_bf16 v[56:59], v[144:147], v[116:119], v[56:59]
  ds_read_b128 v[136:139], v33 offset:6144
  v_mfma_f32_16x16x32_bf16 v[76:79], v[148:151], v[116:119], v[76:79]
  ds_read_b128 v[140:143], v36 offset:12288
  v_mfma_f32_16x16x32_bf16 v[96:99], v[116:119], v[152:155], v[96:99]
  s_cmp_lg_u32 s97, 6
  s_cbranch_scc1 Lres10
  ds_read_b128 v[12:15], v198
  ds_read_b128 v[16:19], v199
Lres10:
  buffer_load_dwordx4 v6, s[12:15], s62 offen offset:3072 lds
  v_mfma_f32_16x16x32_bf16 v[60:63], v[144:147], v[120:123], v[60:63]
  v_mfma_f32_16x16x32_bf16 v[80:83], v[148:151], v[120:123], v[80:83]
  v_mfma_f32_16x16x32_bf16 v[100:103], v[120:123], v[152:155], v[100:103]
  s_waitcnt vmcnt(6)
  s_waitcnt lgkmcnt(0)
  s_barrier
  v_mfma_f32_16x16x32_bf16 v[44:47], v[156:159], v[124:127], v[44:47]
  ds_read_b64_tr_b16 v[144:145], v34 offset:32768
  s_xor_b32 s62, s100, 4096
  s_add_u32 m0, s62, 0
  s_xor_b32 s62, s101, 32768
  buffer_load_dwordx4 v3, s[12:15], s62 offen offset:0 lds
  v_mfma_f32_16x16x32_bf16 v[64:67], v[160:163], v[124:127], v[64:67]
  ds_read_b64_tr_b16 v[146:147], v34 offset:33280
  v_mfma_f32_16x16x32_bf16 v[84:87], v[124:127], v[164:167], v[84:87]
  ds_read_b128 v[104:107], v32 offset:32768
  v_mfma_f32_16x16x32_bf16 v[48:51], v[156:159], v[128:131], v[48:51]
  ds_read_b64_tr_b16 v[148:149], v34 offset:33792
  v_mfma_f32_16x16x32_bf16 v[68:71], v[160:163], v[128:131], v[68:71]
  ds_read_b64_tr_b16 v[150:151], v34 offset:34304
  buffer_load_dwordx4 v4, s[12:15], s62 offen offset:1024 lds
  v_mfma_f32_16x16x32_bf16 v[88:91], v[128:131], v[164:167], v[88:91]
  ds_read_b64_tr_b16 v[152:153], v34 offset:34816
  v_mfma_f32_16x16x32_bf16 v[52:55], v[156:159], v[132:135], v[52:55]
  ds_read_b64_tr_b16 v[154:155], v34 offset:35328
  v_mfma_f32_16x16x32_bf16 v[72:75], v[160:163], v[132:135], v[72:75]
  ds_read_b128 v[108:111], v32 offset:34816
  v_mfma_f32_16x16x32_bf16 v[92:95], v[132:135], v[164:167], v[92:95]
  ds_read_b128 v[112:115], v32 offset:36864
  buffer_load_dwordx4 v5, s[12:15], s62 offen offset:2048 lds
  v_mfma_f32_16x16x32_bf16 v[56:59], v[156:159], v[136:139], v[56:59]
  ds_read_b128 v[116:119], v32 offset:38912
  v_mfma_f32_16x16x32_bf16 v[76:79], v[160:163], v[136:139], v[76:79]
  ds_read_b128 v[120:123], v35 offset:14336
  v_mfma_f32_16x16x32_bf16 v[96:99], v[136:139], v[164:167], v[96:99]
  v_mfma_f32_16x16x32_bf16 v[60:63], v[156:159], v[140:143], v[60:63]
  buffer_load_dwordx4 v6, s[12:15], s62 offen offset:3072 lds
  v_mfma_f32_16x16x32_bf16 v[80:83], v[160:163], v[140:143], v[80:83]
  v_mfma_f32_16x16x32_bf16 v[100:103], v[140:143], v[164:167], v[100:103]
  s_waitcnt lgkmcnt(3)
  v_mfma_f32_16x16x32_bf16 v[44:47], v[144:147], v[104:107], v[44:47]
  ds_read_b64_tr_b16 v[156:157], v34 offset:45056
  v_mfma_f32_16x16x32_bf16 v[64:67], v[148:151], v[104:107], v[64:67]
  ds_read_b64_tr_b16 v[158:159], v34 offset:45568
  s_xor_b32 s62, s100, 0
  s_add_u32 m0, s62, 32768
  s_xor_b32 s62, s101, 262144
  buffer_load_dwordx4 v3, s[12:15], s62 offen offset:0 lds
  v_mfma_f32_16x16x32_bf16 v[84:87], v[104:107], v[152:155], v[84:87]
  ds_read_b128 v[124:127], v33 offset:32768
  v_mfma_f32_16x16x32_bf16 v[48:51], v[144:147], v[108:111], v[48:51]
  ds_read_b64_tr_b16 v[160:161], v34 offset:46080
  v_mfma_f32_16x16x32_bf16 v[68:71], v[148:151], v[108:111], v[68:71]
  ds_read_b64_tr_b16 v[162:163], v34 offset:46592
  v_mfma_f32_16x16x32_bf16 v[88:91], v[108:111], v[152:155], v[88:91]
  ds_read_b64_tr_b16 v[164:165], v34 offset:47104
  buffer_load_dwordx4 v4, s[12:15], s62 offen offset:1024 lds
  s_waitcnt lgkmcnt(6)
  v_mfma_f32_16x16x32_bf16 v[52:55], v[144:147], v[112:115], v[52:55]
  ds_read_b64_tr_b16 v[166:167], v34 offset:47616
  v_mfma_f32_16x16x32_bf16 v[72:75], v[148:151], v[112:115], v[72:75]
  ds_read_b128 v[128:131], v33 offset:34816
  v_mfma_f32_16x16x32_bf16 v[92:95], v[112:115], v[152:155], v[92:95]
  ds_read_b128 v[132:135], v33 offset:36864
  v_mfma_f32_16x16x32_bf16 v[56:59], v[144:147], v[116:119], v[56:59]
  ds_read_b128 v[136:139], v33 offset:38912
  buffer_load_dwordx4 v5, s[12:15], s62 offen offset:2048 lds
  v_mfma_f32_16x16x32_bf16 v[76:79], v[148:151], v[116:119], v[76:79]
  ds_read_b128 v[140:143], v36 offset:14336
  v_mfma_f32_16x16x32_bf16 v[96:99], v[116:119], v[152:155], v[96:99]
  s_cmp_lg_u32 s97, 7
  s_cbranch_scc1 Lres11
  ds_read_b128 v[12:15], v198
  ds_read_b128 v[16:19], v199
Lres11:
  v_mfma_f32_16x16x32_bf16 v[60:63], v[144:147], v[120:123], v[60:63]
  v_mfma_f32_16x16x32_bf16 v[80:83], v[148:151], v[120:123], v[80:83]
  buffer_load_dwordx4 v6, s[12:15], s62 offen offset:3072 lds
  v_mfma_f32_16x16x32_bf16 v[100:103], v[120:123], v[152:155], v[100:103]
  s_waitcnt lgkmcnt(0)
  s_barrier
  v_mfma_f32_16x16x32_bf16 v[60:63], v[156:159], v[140:143], v[60:63]
  ds_read2_b32 v[104:105], v186 offset0:0 offset1:80
  v_mfma_f32_16x16x32_bf16 v[80:83], v[160:163], v[140:143], v[80:83]
  ds_read2_b32 v[106:107], v186 offset0:16 offset1:96
  v_mfma_f32_16x16x32_bf16 v[100:103], v[140:143], v[164:167], v[100:103]
  ds_read2_b32 v[108:109], v186 offset0:32 offset1:112
  s_xor_b32 s62, s100, 4096
  s_add_u32 m0, s62, 32768
  s_xor_b32 s62, s101, 294912
  buffer_load_dwordx4 v3, s[12:15], s62 offen offset:0 lds
  v_mfma_f32_16x16x32_bf16 v[44:47], v[156:159], v[124:127], v[44:47]
  ds_read2_b32 v[110:111], v186 offset0:48 offset1:128
  v_mfma_f32_16x16x32_bf16 v[64:67], v[160:163], v[124:127], v[64:67]
  ds_read2_b32 v[112:113], v186 offset0:64 offset1:144
  v_mfma_f32_16x16x32_bf16 v[84:87], v[124:127], v[164:167], v[84:87]
  ds_read_b128 v[114:117], v187 offset:256
  v_mfma_f32_16x16x32_bf16 v[48:51], v[156:159], v[128:131], v[48:51]
  ds_read_b128 v[118:121], v187 offset:576
  buffer_load_dwordx4 v4, s[12:15], s62 offen offset:1024 lds
  v_mfma_f32_16x16x32_bf16 v[68:71], v[160:163], v[128:131], v[68:71]
  ds_read_b128 v[144:147], v187 offset:0
  v_mfma_f32_16x16x32_bf16 v[88:91], v[128:131], v[164:167], v[88:91]
  ds_read_b128 v[148:151], v187 offset:320
  v_mfma_f32_16x16x32_bf16 v[52:55], v[156:159], v[132:135], v[52:55]
  ds_read_b128 v[152:155], v187 offset:64
  v_mfma_f32_16x16x32_bf16 v[72:75], v[160:163], v[132:135], v[72:75]
  ds_read_b128 v[224:227], v187 offset:384
  buffer_load_dwordx4 v5, s[12:15], s62 offen offset:2048 lds
  v_mfma_f32_16x16x32_bf16 v[92:95], v[132:135], v[164:167], v[92:95]
  ds_read_b128 v[228:231], v187 offset:128
  v_mfma_f32_16x16x32_bf16 v[56:59], v[156:159], v[136:139], v[56:59]
  ds_read_b128 v[232:235], v187 offset:448
  v_mfma_f32_16x16x32_bf16 v[76:79], v[160:163], v[136:139], v[76:79]
  ds_read_b128 v[236:239], v187 offset:192
  v_mfma_f32_16x16x32_bf16 v[96:99], v[136:139], v[164:167], v[96:99]
  ds_read_b128 v[240:243], v187 offset:512
  buffer_load_dwordx4 v6, s[12:15], s62 offen offset:3072 lds
  v_mov_b32_dpp v156, v60 row_newbcast:0 row_mask:0xf bank_mask:0xf
  v_mov_b32_dpp v157, v61 row_newbcast:0 row_mask:0xf bank_mask:0xf
  v_mov_b32_dpp v158, v62 row_newbcast:0 row_mask:0xf bank_mask:0xf
  v_mov_b32_dpp v159, v63 row_newbcast:0 row_mask:0xf bank_mask:0xf
  v_mov_b32_dpp v160, v80 row_newbcast:0 row_mask:0xf bank_mask:0xf
  v_mov_b32_dpp v161, v81 row_newbcast:0 row_mask:0xf bank_mask:0xf
  v_mov_b32_dpp v162, v82 row_newbcast:0 row_mask:0xf bank_mask:0xf
  v_mov_b32_dpp v163, v83 row_newbcast:0 row_mask:0xf bank_mask:0xf
  v_mov_b32_e64 v164, v100
  v_mov_b32 v165, v100
  s_waitcnt lgkmcnt(10)
  v_pk_fma_f32 v[44:45], v[104:105], v[156:157], v[44:45] op_sel_hi:[0,1,1] neg_lo:[1,0,0] neg_hi:[1,0,0]
  v_pk_fma_f32 v[46:47], v[104:105], v[158:159], v[46:47] op_sel_hi:[0,1,1] neg_lo:[1,0,0] neg_hi:[1,0,0]
  s_add_u32 s50, s90, Lpf2-Lpc9
  s_min_u32 s50, s50, Lend-Lpc9
  s_getpc_b64 s[48:49]
Lpc9:
  s_add_u32 s48, s48, s50
  s_addc_u32 s49, s49, 0
  v_mov_b32 v244, s48
  v_mov_b32 v245, s49
  s_mov_b64 exec, 1
  global_load_dword v246, v[244:245], off
  s_mov_b64 exec, -1
  v_pk_fma_f32 v[48:49], v[106:107], v[156:157], v[48:49] op_sel_hi:[0,1,1] neg_lo:[1,0,0] neg_hi:[1,0,0]
  s_add_u32 m0, s66, 65536
  s_add_u32 s62, s67, 0
  buffer_load_dwordx4 v7, s[16:19], s62 offen offset:0 lds
  v_pk_fma_f32 v[50:51], v[106:107], v[158:159], v[50:51] op_sel_hi:[0,1,1] neg_lo:[1,0,0] neg_hi:[1,0,0]
  v_pk_fma_f32 v[52:53], v[108:109], v[156:157], v[52:53] op_sel_hi:[0,1,1] neg_lo:[1,0,0] neg_hi:[1,0,0]
  v_pk_fma_f32 v[54:55], v[108:109], v[158:159], v[54:55] op_sel_hi:[0,1,1] neg_lo:[1,0,0] neg_hi:[1,0,0]
  v_pk_fma_f32 v[56:57], v[110:111], v[156:157], v[56:57] op_sel_hi:[0,1,1] neg_lo:[1,0,0] neg_hi:[1,0,0]
  v_pk_fma_f32 v[58:59], v[110:111], v[158:159], v[58:59] op_sel_hi:[0,1,1] neg_lo:[1,0,0] neg_hi:[1,0,0]
  v_permlane16_swap_b32 v164, v165
  s_nop 0
  v_pk_fma_f32 v[64:65], v[104:105], v[160:161], v[64:65] op_sel_hi:[0,1,1] neg_lo:[1,0,0] neg_hi:[1,0,0]
  v_pk_fma_f32 v[66:67], v[104:105], v[162:163], v[66:67] op_sel_hi:[0,1,1] neg_lo:[1,0,0] neg_hi:[1,0,0]
  v_pk_fma_f32 v[68:69], v[106:107], v[160:161], v[68:69] op_sel_hi:[0,1,1] neg_lo:[1,0,0] neg_hi:[1,0,0]
  v_pk_fma_f32 v[70:71], v[106:107], v[162:163], v[70:71] op_sel_hi:[0,1,1] neg_lo:[1,0,0] neg_hi:[1,0,0]
  v_pk_fma_f32 v[72:73], v[108:109], v[160:161], v[72:73] op_sel_hi:[0,1,1] neg_lo:[1,0,0] neg_hi:[1,0,0]
  v_pk_fma_f32 v[74:75], v[108:109], v[162:163], v[74:75] op_sel_hi:[0,1,1] neg_lo:[1,0,0] neg_hi:[1,0,0]
  v_pk_fma_f32 v[76:77], v[110:111], v[160:161], v[76:77] op_sel_hi:[0,1,1] neg_lo:[1,0,0] neg_hi:[1,0,0]
  v_pk_fma_f32 v[78:79], v[110:111], v[162:163], v[78:79] op_sel_hi:[0,1,1] neg_lo:[1,0,0] neg_hi:[1,0,0]
  v_pk_fma_f32 v[80:81], v[112:113], v[160:161], v[80:81] op_sel_hi:[0,1,1] neg_lo:[1,0,0] neg_hi:[1,0,0]
  v_pk_fma_f32 v[82:83], v[112:113], v[162:163], v[82:83] op_sel_hi:[0,1,1] neg_lo:[1,0,0] neg_hi:[1,0,0]
  v_pk_mul_f32 v[64:65], v[104:105], v[64:65] op_sel:[1,0]
  v_pk_mul_f32 v[66:67], v[104:105], v[66:67] op_sel:[1,0]
  v_pk_mul_f32 v[68:69], v[106:107], v[68:69] op_sel:[1,0]
  v_pk_mul_f32 v[70:71], v[106:107], v[70:71] op_sel:[1,0]
  v_pk_mul_f32 v[72:73], v[108:109], v[72:73] op_sel:[1,0]
  v_pk_mul_f32 v[74:75], v[108:109], v[74:75] op_sel:[1,0]
  v_pk_mul_f32 v[76:77], v[110:111], v[76:77] op_sel:[1,0]
  buffer_load_dwordx4 v8, s[16:19], s62 offen offset:1024 lds
  v_pk_mul_f32 v[78:79], v[110:111], v[78:79] op_sel:[1,0]
  v_pk_mul_f32 v[80:81], v[112:113], v[80:81] op_sel:[1,0]
  v_pk_mul_f32 v[82:83], v[112:113], v[82:83] op_sel:[1,0]
  s_waitcnt lgkmcnt(8)
  s_nop 0
  v_pk_fma_f32 v[100:101], v[114:115], v[164:165], v[100:101] op_sel_hi:[1,0,1] neg_lo:[1,0,0] neg_hi:[1,0,0]
  v_pk_fma_f32 v[102:103], v[116:117], v[164:165], v[102:103] op_sel_hi:[1,0,1] neg_lo:[1,0,0] neg_hi:[1,0,0]
  v_pk_mul_f32 v[100:101], v[118:119], v[100:101]
  v_pk_mul_f32 v[102:103], v[120:121], v[102:103]
  s_waitcnt lgkmcnt(6)
  v_pk_fma_f32 v[84:85], v[144:145], v[164:165], v[84:85] op_sel_hi:[1,0,1] neg_lo:[1,0,0] neg_hi:[1,0,0]
  v_pk_fma_f32 v[86:87], v[146:147], v[164:165], v[86:87] op_sel_hi:[1,0,1] neg_lo:[1,0,0] neg_hi:[1,0,0]
  v_pk_mul_f32 v[84:85], v[148:149], v[84:85]
  v_pk_mul_f32 v[86:87], v[150:151], v[86:87]
  s_waitcnt lgkmcnt(4)
  v_pk_fma_f32 v[88:89], v[152:153], v[164:165], v[88:89] op_sel_hi:[1,0,1] neg_lo:[1,0,0] neg_hi:[1,0,0]
  v_pk_fma_f32 v[90:91], v[154:155], v[164:165], v[90:91] op_sel_hi:[1,0,1] neg_lo:[1,0,0] neg_hi:[1,0,0]
  v_pk_mul_f32 v[88:89], v[224:225], v[88:89]
  v_pk_mul_f32 v[90:91], v[226:227], v[90:91]
  s_waitcnt lgkmcnt(2)
  v_pk_fma_f32 v[92:93], v[228:229], v[164:165], v[92:93] op_sel_hi:[1,0,1] neg_lo:[1,0,0] neg_hi:[1,0,0]
  v_pk_fma_f32 v[94:95], v[230:231], v[164:165], v[94:95] op_sel_hi:[1,0,1] neg_lo:[1,0,0] neg_hi:[1,0,0]
  v_pk_mul_f32 v[92:93], v[232:233], v[92:93]
  v_pk_mul_f32 v[94:95], v[234:235], v[94:95]
  s_waitcnt lgkmcnt(0)
  buffer_load_dwordx4 v9, s[16:19], s62 offen offset:2048 lds
  v_pk_fma_f32 v[96:97], v[236:237], v[164:165], v[96:97] op_sel_hi:[1,0,1] neg_lo:[1,0,0] neg_hi:[1,0,0]
  v_pk_fma_f32 v[98:99], v[238:239], v[164:165], v[98:99] op_sel_hi:[1,0,1] neg_lo:[1,0,0] neg_hi:[1,0,0]
  v_pk_mul_f32 v[96:97], v[240:241], v[96:97]
  v_pk_mul_f32 v[98:99], v[242:243], v[98:99]
  v_cvt_pk_bf16_f32 v168, v44, v45
  v_cvt_pk_bf16_f32 v169, v46, v47
  v_cvt_pk_bf16_f32 v170, v48, v49
  v_cvt_pk_bf16_f32 v171, v50, v51
  v_cvt_pk_bf16_f32 v172, v52, v53
  v_cvt_pk_bf16_f32 v173, v54, v55
  v_cvt_pk_bf16_f32 v174, v56, v57
  v_cvt_pk_bf16_f32 v175, v58, v59
  v_cvt_pk_bf16_f32 v184, v80, v81
  v_cvt_pk_bf16_f32 v185, v82, v83
  v_cvt_pk_bf16_f32 v176, v64, v65
  v_cvt_pk_bf16_f32 v177, v66, v67
  v_cvt_pk_bf16_f32 v178, v68, v69
  v_cvt_pk_bf16_f32 v179, v70, v71
  v_cvt_pk_bf16_f32 v180, v72, v73
  v_cvt_pk_bf16_f32 v181, v74, v75
  v_cvt_pk_bf16_f32 v182, v76, v77
  v_cvt_pk_bf16_f32 v183, v78, v79
  v_mfma_f32_16x16x16_bf16 v[44:47], v[184:185], v[168:169], v[208:211]
  buffer_load_dwordx4 v10, s[16:19], s62 offen offset:3072 lds
  v_cvt_pk_bf16_f32 v186, v100, v101
  v_cvt_pk_bf16_f32 v192, v100, v101
  v_mfma_f32_16x16x16_bf16 v[48:51], v[176:177], v[168:169], v[200:203]
  v_cvt_pk_bf16_f32 v187, v102, v103
  v_cvt_pk_bf16_f32 v193, v102, v103
  v_mfma_f32_16x16x16_bf16 v[52:55], v[184:185], v[170:171], v[212:215]
  v_cvt_pk_bf16_f32 v188, v84, v85
  v_cvt_pk_bf16_f32 v189, v86, v87
  v_mfma_f32_16x16x16_bf16 v[56:59], v[178:179], v[170:171], v[200:203]
  v_cvt_pk_bf16_f32 v194, v88, v89
  v_cvt_pk_bf16_f32 v195, v90, v91
  v_mfma_f32_16x16x16_bf16 v[60:63], v[176:177], v[172:173], v[204:207]
  v_cvt_pk_bf16_f32 v190, v92, v93
  v_cvt_pk_bf16_f32 v191, v94, v95
  v_mfma_f32_16x16x16_bf16 v[64:67], v[180:181], v[172:173], v[200:203]
  v_cvt_pk_bf16_f32 v196, v96, v97
  v_cvt_pk_bf16_f32 v197, v98, v99
  v_mfma_f32_16x16x16_bf16 v[68:71], v[178:179], v[174:175], v[204:207]
  s_add_u32 m0, s66, 81920
  s_add_u32 s62, s67, 229376
  buffer_load_dwordx4 v7, s[16:19], s62 offen offset:0 lds
  v_mul_f32 v232, 0x3eb8aa3b, v105
  v_mul_f32 v234, 0x3eb8aa3b, v107
  v_mfma_f32_16x16x16_bf16 v[72:75], v[182:183], v[174:175], v[200:203]
  v_mul_f32 v236, 0x3eb8aa3b, v109
  v_mul_f32 v238, 0x3eb8aa3b, v111
  v_max_f32 v48, v48, v44
  v_max_f32 v49, v49, v45
  v_max_f32 v50, v50, v46
  v_max_f32 v51, v51, v47
  v_max_f32 v56, v56, v52
  v_max_f32 v57, v57, v53
  v_max_f32 v58, v58, v54
  v_max_f32 v59, v59, v55
  v_max_f32 v64, v64, v60
  v_max_f32 v65, v65, v61
  v_max_f32 v66, v66, v62
  v_max_f32 v67, v67, v63
  v_max_f32 v72, v72, v68
  v_max_f32 v73, v73, v69
  v_max_f32 v74, v74, v70
  v_max_f32 v75, v75, v71
  v_max3_f32 v228, v48, v49, v50
  v_max3_f32 v229, v56, v57, v58
  buffer_load_dwordx4 v8, s[16:19], s62 offen offset:1024 lds
  v_max3_f32 v230, v64, v65, v66
  v_max3_f32 v231, v72, v73, v74
  v_max_f32 v228, v228, v51
  v_max_f32 v229, v229, v59
  v_max_f32 v230, v230, v67
  v_max_f32 v231, v231, v75
  v_permlane32_swap_b32 v228, v229
  s_nop 0
  v_permlane32_swap_b32 v230, v231
  v_max_f32 v228, v228, v229
  v_max_f32 v230, v230, v231
  s_nop 1
  v_permlane16_swap_b32 v228, v230
  v_max_f32 v228, v228, v230
  v_mov_b32 v230, v228
  s_nop 1
  v_permlane16_swap_b32 v228, v230
  v_mov_b32 v229, v228
  v_mov_b32 v231, v230
  s_nop 0
  v_permlane32_swap_b32 v228, v229
  v_permlane32_swap_b32 v230, v231
  buffer_load_dwordx4 v9, s[16:19], s62 offen offset:2048 lds
  v_mul_f32 v233, v232, v228
  v_mul_f32 v235, v234, v229
  v_mul_f32 v237, v236, v230
  v_mul_f32 v239, v238, v231
  v_pk_fma_f32 v[48:49], v[48:49], v[232:233], v[232:233] op_sel:[0,0,1] op_sel_hi:[1,0,1] neg_lo:[0,0,1] neg_hi:[0,0,1]
  v_pk_fma_f32 v[50:51], v[50:51], v[232:233], v[232:233] op_sel:[0,0,1] op_sel_hi:[1,0,1] neg_lo:[0,0,1] neg_hi:[0,0,1]
  v_pk_fma_f32 v[56:57], v[56:57], v[234:235], v[234:235] op_sel:[0,0,1] op_sel_hi:[1,0,1] neg_lo:[0,0,1] neg_hi:[0,0,1]
  v_pk_fma_f32 v[58:59], v[58:59], v[234:235], v[234:235] op_sel:[0,0,1] op_sel_hi:[1,0,1] neg_lo:[0,0,1] neg_hi:[0,0,1]
  v_pk_fma_f32 v[64:65], v[64:65], v[236:237], v[236:237] op_sel:[0,0,1] op_sel_hi:[1,0,1] neg_lo:[0,0,1] neg_hi:[0,0,1]
  v_pk_fma_f32 v[66:67], v[66:67], v[236:237], v[236:237] op_sel:[0,0,1] op_sel_hi:[1,0,1] neg_lo:[0,0,1] neg_hi:[0,0,1]
  v_pk_fma_f32 v[72:73], v[72:73], v[238:239], v[238:239] op_sel:[0,0,1] op_sel_hi:[1,0,1] neg_lo:[0,0,1] neg_hi:[0,0,1]
  v_pk_fma_f32 v[74:75], v[74:75], v[238:239], v[238:239] op_sel:[0,0,1] op_sel_hi:[1,0,1] neg_lo:[0,0,1] neg_hi:[0,0,1]
  v_exp_f32 v48, v48
  v_exp_f32 v49, v49
  v_exp_f32 v50, v50
  v_exp_f32 v51, v51
  v_exp_f32 v56, v56
  v_exp_f32 v57, v57
  buffer_load_dwordx4 v10, s[16:19], s62 offen offset:3072 lds
  v_exp_f32 v58, v58
  v_exp_f32 v59, v59
  v_exp_f32 v64, v64
  v_exp_f32 v65, v65
  v_exp_f32 v66, v66
  v_exp_f32 v67, v67
  v_exp_f32 v72, v72
  v_exp_f32 v73, v73
  v_exp_f32 v74, v74
  v_exp_f32 v75, v75
  v_cvt_pk_bf16_f32 v44, v48, v49
  v_cvt_pk_bf16_f32 v45, v50, v51
  v_cvt_pk_bf16_f32 v52, v56, v57
  v_cvt_pk_bf16_f32 v53, v58, v59
  s_add_u32 m0, s66, 98304
  s_add_u32 s62, s67, 458752
  buffer_load_dwordx4 v7, s[16:19], s62 offen offset:0 lds
  v_cvt_pk_bf16_f32 v60, v64, v65
  v_cvt_pk_bf16_f32 v61, v66, v67
  v_cvt_pk_bf16_f32 v68, v72, v73
  v_cvt_pk_bf16_f32 v69, v74, v75
  v_bfi_b32 v104, v216, 0, v44
  v_and_b32_e64 v106, v216, v44
  v_bfi_b32 v105, v217, 0, v45
  v_and_b32_e64 v107, v217, v45
  v_bfi_b32 v108, v216, 0, v52
  v_and_b32_e64 v110, v216, v52
  v_bfi_b32 v109, v217, 0, v53
  v_and_b32_e64 v111, v217, v53
  v_bfi_b32 v112, v216, 0, v60
  v_and_b32_e64 v114, v216, v60
  v_bfi_b32 v113, v217, 0, v61
  v_and_b32_e64 v115, v217, v61
  v_bfi_b32 v116, v216, 0, v68
  v_and_b32_e64 v118, v216, v68
  v_bfi_b32 v117, v217, 0, v69
  v_and_b32_e64 v119, v217, v69
  v_mfma_f32_16x16x32_bf16 v[124:127], v[220:223], v[104:107], 0
  v_mfma_f32_16x16x32_bf16 v[120:123], v[186:189], v[104:107], 0
  buffer_load_dwordx4 v8, s[16:19], s62 offen offset:1024 lds
  v_mfma_f32_16x16x32_bf16 v[132:135], v[220:223], v[108:111], 0
  v_mfma_f32_16x16x32_bf16 v[128:131], v[192:195], v[108:111], 0
  v_mfma_f32_16x16x32_bf16 v[140:143], v[220:223], v[112:115], 0
  v_mfma_f32_16x16x32_bf16 v[136:139], v[188:191], v[112:115], 0
  v_mfma_f32_16x16x32_bf16 v[148:151], v[220:223], v[116:119], 0
  v_mfma_f32_16x16x32_bf16 v[144:147], v[194:197], v[116:119], 0
  v_rcp_f32_e64 v124, v124
  buffer_load_dwordx4 v9, s[16:19], s62 offen offset:2048 lds
  s_nop 0
  v_rcp_f32 v132, v132
  s_nop 0
  v_rcp_f32 v140, v140
  s_nop 0
  v_rcp_f32 v148, v148
  v_pk_mul_f32 v[120:121], v[124:125], v[120:121] op_sel_hi:[0,1]
  v_pk_mul_f32 v[122:123], v[124:125], v[122:123] op_sel_hi:[0,1]
  v_pk_mul_f32 v[128:129], v[132:133], v[128:129] op_sel_hi:[0,1]
  v_pk_mul_f32 v[130:131], v[132:133], v[130:131] op_sel_hi:[0,1]
  v_pk_mul_f32 v[136:137], v[140:141], v[136:137] op_sel_hi:[0,1]
  v_pk_mul_f32 v[138:139], v[140:141], v[138:139] op_sel_hi:[0,1]
  v_pk_mul_f32 v[144:145], v[148:149], v[144:145] op_sel_hi:[0,1]
  v_pk_mul_f32 v[146:147], v[148:149], v[146:147] op_sel_hi:[0,1]
  v_cvt_pk_bf16_f32 v152, v120, v121
  v_cvt_pk_bf16_f32 v153, v122, v123
  v_cvt_pk_bf16_f32 v154, v128, v129
  v_cvt_pk_bf16_f32 v155, v130, v131
  v_cvt_pk_bf16_f32 v156, v136, v137
  v_cvt_pk_bf16_f32 v157, v138, v139
  v_cvt_pk_bf16_f32 v158, v144, v145
  v_cvt_pk_bf16_f32 v159, v146, v147
  v_permlane16_swap_b32 v152, v154
  buffer_load_dwordx4 v10, s[16:19], s62 offen offset:3072 lds
  v_permlane16_swap_b32 v153, v155
  v_permlane16_swap_b32 v156, v158
  v_permlane16_swap_b32 v157, v159
  s_cmp_eq_u32 s96, 0
  s_cbranch_scc1 Lfar12
  buffer_store_dwordx4 v[152:155], v2, s[32:35], s36 offen
  buffer_store_dwordx4 v[156:159], v2, s[32:35], s37 offen
Lback13:
  s_mov_b32 exec_lo, 0xffff0000
  s_mov_b32 exec_hi, 0x3
  buffer_load_dword v250, v249, s[32:35], 0 offen
  s_mov_b64 exec, -1
Lpf2:
  s_mov_b32 s18, 1835008
  s_lshl_b32 s50, s43, 8
  s_lshr_b32 s51, s44, 2
  s_lshl_b32 s51, s51, 7
  s_add_u32 s52, s50, s51
  s_and_b32 s51, s44, 3
  s_lshl2_add_u32 s51, s51, s40
  s_lshl2_add_u32 s52, s51, s52
  s_lshl_b32 s51, s47, 7
  s_add_u32 s58, s50, s51
  v_bfe_u32 v20, v1, 2, 2
  v_and_b32 v21, 1, v1
  v_lshlrev_b32_e64 v21, 1, v21
  v_bfe_u32 v22, v1, 4, 1
  v_add_u32 v21, v21, v22
  v_lshrrev_b32 v22, 1, v20
  v_xor_b32_e64 v22, s47, v22
  v_lshl_add_u32 v21, v22, 2, v21
  v_lshlrev_b32_e64 v21, 4, v21
  v_bfe_u32 v22, v1, 1, 1
  v_lshl_add_u32 v21, v22, 3, v21
  v_lshrrev_b32_e64 v22, 5, v1
  v_lshl_add_u32 v20, v22, 3, v20
  v_lshl_add_u32 v24, v20, 7, v21
  s_lshr_b32 s50, s101, 18
  s_xor_b32 s50, s50, s47
  s_lshl_b32 s50, s50, 15
  v_add_u32 v24, s50, v24
  v_xor_b32 v25, 64, v24
  s_waitcnt vmcnt(16)
  s_barrier
  s_waitcnt vmcnt(1)
  s_mov_b64 exec, 1
  s_add_u32 s53, s52, 65536
  s_cmp_eq_u32 s96, 0
  s_cbranch_scc1 Lfar14
  buffer_store_dword v251, off, s[32:35], s53
Lback15:
  s_mov_b64 exec, -1
  ds_read_b64_tr_b16 a[128:129], v24 offset:0
  ds_read_b64_tr_b16 a[130:131], v24 offset:512
  ds_read_b64_tr_b16 a[132:133], v25 offset:0
  ds_read_b64_tr_b16 a[134:135], v25 offset:512
  ds_read_b64_tr_b16 a[136:137], v24 offset:2048
  ds_read_b64_tr_b16 a[138:139], v24 offset:2560
  ds_read_b64_tr_b16 a[140:141], v25 offset:2048
  ds_read_b64_tr_b16 a[142:143], v25 offset:2560
  ds_read_b64_tr_b16 a[144:145], v24 offset:4096
  s_add_u32 m0, s66, 114688
  s_add_u32 s62, s67, 688128
  buffer_load_dwordx4 v7, s[16:19], s62 offen offset:0 lds
  ds_read_b64_tr_b16 a[146:147], v24 offset:4608
  ds_read_b64_tr_b16 a[148:149], v25 offset:4096
  ds_read_b64_tr_b16 a[150:151], v25 offset:4608
  ds_read_b64_tr_b16 a[152:153], v24 offset:6144
  ds_read_b64_tr_b16 a[154:155], v24 offset:6656
  ds_read_b64_tr_b16 a[156:157], v25 offset:6144
  ds_read_b64_tr_b16 a[158:159], v25 offset:6656
  ds_read_b64_tr_b16 a[160:161], v24 offset:8192
  ds_read_b64_tr_b16 a[162:163], v24 offset:8704
  ds_read_b64_tr_b16 a[164:165], v25 offset:8192
  ds_read_b64_tr_b16 a[166:167], v25 offset:8704
  ds_read_b64_tr_b16 a[168:169], v24 offset:10240
  buffer_load_dwordx4 v8, s[16:19], s62 offen offset:1024 lds
  ds_read_b64_tr_b16 a[170:171], v24 offset:10752
  ds_read_b64_tr_b16 a[172:173], v25 offset:10240
  ds_read_b64_tr_b16 a[174:175], v25 offset:10752
  buffer_load_dwordx4 v9, s[16:19], s62 offen offset:2048 lds
  buffer_load_dwordx4 v10, s[16:19], s62 offen offset:3072 lds
  s_add_u32 s38, s58, 65536
  buffer_load_dword v255, v253, s[32:35], s38 offen sc1
  ds_read_b64_tr_b16 a[176:177], v24 offset:12288
  ds_read_b64_tr_b16 a[178:179], v24 offset:12800
  ds_read_b64_tr_b16 a[180:181], v25 offset:12288
  ds_read_b64_tr_b16 a[182:183], v25 offset:12800
  ds_read_b64_tr_b16 a[184:185], v24 offset:14336
  ds_read_b64_tr_b16 a[186:187], v24 offset:14848
  ds_read_b64_tr_b16 a[188:189], v25 offset:14336
  ds_read_b64_tr_b16 a[190:191], v25 offset:14848
  ds_read_b64_tr_b16 a[192:193], v24 offset:16384
  ds_read_b64_tr_b16 a[194:195], v24 offset:16896
  ds_read_b64_tr_b16 a[196:197], v25 offset:16384
  ds_read_b64_tr_b16 a[198:199], v25 offset:16896
  ds_read_b64_tr_b16 a[200:201], v24 offset:18432
  ds_read_b64_tr_b16 a[202:203], v24 offset:18944
  ds_read_b64_tr_b16 a[204:205], v25 offset:18432
  ds_read_b64_tr_b16 a[206:207], v25 offset:18944
  ds_read_b64_tr_b16 a[208:209], v24 offset:20480
  ds_read_b64_tr_b16 a[210:211], v24 offset:20992
  ds_read_b64_tr_b16 a[212:213], v25 offset:20480
  ds_read_b64_tr_b16 a[214:215], v25 offset:20992
  ds_read_b64_tr_b16 a[216:217], v24 offset:22528
  ds_read_b64_tr_b16 a[218:219], v24 offset:23040
  ds_read_b64_tr_b16 a[220:221], v25 offset:22528
  ds_read_b64_tr_b16 a[222:223], v25 offset:23040
  ds_read_b64_tr_b16 a[224:225], v24 offset:24576
  ds_read_b64_tr_b16 a[226:227], v24 offset:25088
  ds_read_b64_tr_b16 a[228:229], v25 offset:24576
  ds_read_b64_tr_b16 a[230:231], v25 offset:25088
  ds_read_b64_tr_b16 a[232:233], v24 offset:26624
  ds_read_b64_tr_b16 a[234:235], v24 offset:27136
  ds_read_b64_tr_b16 a[236:237], v25 offset:26624
  ds_read_b64_tr_b16 a[238:239], v25 offset:27136
  ds_read_b64_tr_b16 a[240:241], v24 offset:28672
  ds_read_b64_tr_b16 a[242:243], v24 offset:29184
  ds_read_b64_tr_b16 a[244:245], v25 offset:28672
  ds_read_b64_tr_b16 a[246:247], v25 offset:29184
  ds_read_b64_tr_b16 a[248:249], v24 offset:30720
  ds_read_b64_tr_b16 a[250:251], v24 offset:31232
  ds_read_b64_tr_b16 a[252:253], v25 offset:30720
  ds_read_b64_tr_b16 a[254:255], v25 offset:31232
  s_lshl_b32 s20, s68, 15
  s_lshl_b32 s51, s47, 14
  s_add_u32 s20, s20, s51
  v_lshlrev_b32 v44, 16, v12
  v_and_b32 v45, 0xffff0000, v12
  v_lshlrev_b32_e64 v46, 16, v13
  v_and_b32 v47, 0xffff0000, v13
  v_lshlrev_b32_e64 v48, 16, v14
  v_and_b32 v49, 0xffff0000, v14
  v_lshlrev_b32_e64 v50, 16, v15
  v_and_b32 v51, 0xffff0000, v15
  v_lshlrev_b32_e64 v52, 16, v16
  v_and_b32 v53, 0xffff0000, v16
  v_lshlrev_b32_e64 v54, 16, v17
  v_and_b32 v55, 0xffff0000, v17
  v_lshlrev_b32_e64 v56, 16, v18
  v_and_b32 v57, 0xffff0000, v18
  v_lshlrev_b32_e64 v58, 16, v19
  v_and_b32 v59, 0xffff0000, v19
  s_xor_b32 s50, s40, 1
  s_lshl_b32 s50, s50, 12
  s_add_u32 s50, s50, 147456
  v_add_u32_e64 v33, s50, v2
  v_xor_b32 v34, 4096, v33
  s_add_u32 s48, s39, 3145728
  s_lshr_b32 s49, s39, 13
  s_lshl_b32 s49, s49, 10
  s_bfe_u32 s50, s39, 0x2000b
  s_lshl2_add_u32 s49, s50, s49
  s_add_u32 s49, s49, 262144
  s_waitcnt lgkmcnt(0)
  s_barrier
  s_mov_b32 s59, 0
  s_waitcnt vmcnt(0)
  v_cmp_ne_u32 vcc, s45, v255
  s_nop 0
  s_cbranch_vccnz Lpoll16
Lpdone17:
  s_add_u32 s63, s20, 1048576
  buffer_load_dwordx4 a[0:3], v2, s[32:35], s63 offen offset:0 sc1
  buffer_load_dwordx4 a[4:7], v2, s[32:35], s63 offen offset:1024 sc1
  buffer_load_dwordx4 a[8:11], v2, s[32:35], s63 offen offset:2048 sc1
  buffer_load_dwordx4 a[12:15], v2, s[32:35], s63 offen offset:3072 sc1
  s_add_u32 s63, s20, 1052672
  buffer_load_dwordx4 a[16:19], v2, s[32:35], s63 offen offset:0 sc1
  buffer_load_dwordx4 a[20:23], v2, s[32:35], s63 offen offset:1024 sc1
  s_waitcnt vmcnt(5)
  v_mfma_f32_32x32x16_bf16 v[60:75], a[132:135], a[0:3], 0
  v_mfma_f32_32x32x16_bf16 v[44:59], a[128:131], a[0:3], v[44:59]
  buffer_load_dwordx4 a[24:27], v2, s[32:35], s63 offen offset:2048 sc1
  s_waitcnt vmcnt(5)
  v_mfma_f32_32x32x16_bf16 v[60:75], a[140:143], a[4:7], v[60:75]
  buffer_load_dwordx4 a[28:31], v2, s[32:35], s63 offen offset:3072 sc1
  v_mfma_f32_32x32x16_bf16 v[44:59], a[136:139], a[4:7], v[44:59]
  s_add_u32 s63, s20, 1056768
  buffer_load_dwordx4 a[32:35], v2, s[32:35], s63 offen offset:0 sc1
  s_waitcnt vmcnt(6)
  v_mfma_f32_32x32x16_bf16 v[60:75], a[148:151], a[8:11], v[60:75]
  buffer_load_dwordx4 a[36:39], v2, s[32:35], s63 offen offset:1024 sc1
  v_mfma_f32_32x32x16_bf16 v[44:59], a[144:147], a[8:11], v[44:59]
  buffer_load_dwordx4 a[40:43], v2, s[32:35], s63 offen offset:2048 sc1
  s_waitcnt vmcnt(7)
  v_mfma_f32_32x32x16_bf16 v[60:75], a[156:159], a[12:15], v[60:75]
  buffer_load_dwordx4 a[44:47], v2, s[32:35], s63 offen offset:3072 sc1
  v_mfma_f32_32x32x16_bf16 v[44:59], a[152:155], a[12:15], v[44:59]
  s_add_u32 s63, s20, 1060864
  buffer_load_dwordx4 a[48:51], v2, s[32:35], s63 offen offset:0 sc1
  s_waitcnt vmcnt(8)
  v_mfma_f32_32x32x16_bf16 v[60:75], a[164:167], a[16:19], v[60:75]
  buffer_load_dwordx4 a[52:55], v2, s[32:35], s63 offen offset:1024 sc1
  v_mfma_f32_32x32x16_bf16 v[44:59], a[160:163], a[16:19], v[44:59]
  buffer_load_dwordx4 a[56:59], v2, s[32:35], s63 offen offset:2048 sc1
  s_waitcnt vmcnt(9)
  v_mfma_f32_32x32x16_bf16 v[60:75], a[172:175], a[20:23], v[60:75]
  buffer_load_dwordx4 a[60:63], v2, s[32:35], s63 offen offset:3072 sc1
  v_mfma_f32_32x32x16_bf16 v[44:59], a[168:171], a[20:23], v[44:59]
  s_add_u32 m0, s66, 131072
  s_add_u32 s62, s98, 917504
  buffer_load_dwordx4 v7, s[16:19], s62 offen offset:0 lds
  s_waitcnt vmcnt(10)
  v_mfma_f32_32x32x16_bf16 v[60:75], a[180:183], a[24:27], v[60:75]
  v_mfma_f32_32x32x16_bf16 v[44:59], a[176:179], a[24:27], v[44:59]
  s_waitcnt vmcnt(9)
  v_mfma_f32_32x32x16_bf16 v[60:75], a[188:191], a[28:31], v[60:75]
  v_mfma_f32_32x32x16_bf16 v[44:59], a[184:187], a[28:31], v[44:59]
  buffer_load_dwordx4 v8, s[16:19], s62 offen offset:1024 lds
  s_waitcnt vmcnt(9)
  v_mfma_f32_32x32x16_bf16 v[60:75], a[196:199], a[32:35], v[60:75]
  v_mfma_f32_32x32x16_bf16 v[44:59], a[192:195], a[32:35], v[44:59]
  s_waitcnt vmcnt(8)
  v_mfma_f32_32x32x16_bf16 v[60:75], a[204:207], a[36:39], v[60:75]
  buffer_load_dwordx4 v9, s[16:19], s62 offen offset:2048 lds
  v_mfma_f32_32x32x16_bf16 v[44:59], a[200:203], a[36:39], v[44:59]
  s_waitcnt vmcnt(8)
  v_mfma_f32_32x32x16_bf16 v[60:75], a[212:215], a[40:43], v[60:75]
  v_mfma_f32_32x32x16_bf16 v[44:59], a[208:211], a[40:43], v[44:59]
  buffer_load_dwordx4 v10, s[16:19], s62 offen offset:3072 lds
  s_waitcnt vmcnt(8)
  v_mfma_f32_32x32x16_bf16 v[60:75], a[220:223], a[44:47], v[60:75]
  v_mfma_f32_32x32x16_bf16 v[44:59], a[216:219], a[44:47], v[44:59]
  s_waitcnt vmcnt(7)
  v_mfma_f32_32x32x16_bf16 v[60:75], a[228:231], a[48:51], v[60:75]
  s_add_u32 m0, s66, 0
  s_add_u32 s62, s98, 1146880
  buffer_load_dwordx4 v7, s[16:19], s62 offen offset:0 lds
  v_mfma_f32_32x32x16_bf16 v[44:59], a[224:227], a[48:51], v[44:59]
  s_waitcnt vmcnt(7)
  v_mfma_f32_32x32x16_bf16 v[60:75], a[236:239], a[52:55], v[60:75]
  v_mfma_f32_32x32x16_bf16 v[44:59], a[232:235], a[52:55], v[44:59]
  buffer_load_dwordx4 v8, s[16:19], s62 offen offset:1024 lds
  s_waitcnt vmcnt(7)
  v_mfma_f32_32x32x16_bf16 v[60:75], a[244:247], a[56:59], v[60:75]
  s_waitcnt vmcnt(6)
  v_mfma_f32_32x32x16_bf16 v[60:75], a[252:255], a[60:63], v[60:75]
  v_mfma_f32_32x32x16_bf16 v[44:59], a[240:243], a[56:59], v[44:59]
  buffer_load_dwordx4 v9, s[16:19], s62 offen offset:2048 lds
  v_mfma_f32_32x32x16_bf16 v[44:59], a[248:251], a[60:63], v[44:59]
  buffer_load_dwordx4 v10, s[16:19], s62 offen offset:3072 lds
  s_add_u32 m0, s66, 16384
  s_add_u32 s62, s98, 1376256
  buffer_load_dwordx4 v7, s[16:19], s62 offen offset:0 lds
  buffer_load_dwordx4 v8, s[16:19], s62 offen offset:1024 lds
  buffer_load_dwordx4 v9, s[16:19], s62 offen offset:2048 lds
  buffer_load_dwordx4 v10, s[16:19], s62 offen offset:3072 lds
  s_nop 1
  ds_write_b128 v33, v[60:63] offset:0
  ds_write_b128 v33, v[64:67] offset:1024
  ds_write_b128 v33, v[68:71] offset:2048
  ds_write_b128 v33, v[72:75] offset:3072
  s_waitcnt lgkmcnt(0)
  s_barrier
  ds_read_b128 v[76:79], v34 offset:0
  ds_read_b128 v[80:83], v34 offset:1024
  ds_read_b128 v[84:87], v34 offset:2048
  ds_read_b128 v[88:91], v34 offset:3072
  s_waitcnt lgkmcnt(3)
  v_pk_add_f32 v[44:45], v[44:45], v[76:77]
  v_pk_add_f32 v[46:47], v[46:47], v[78:79]
  s_waitcnt lgkmcnt(2)
  v_pk_add_f32 v[48:49], v[48:49], v[80:81]
  v_pk_add_f32 v[50:51], v[50:51], v[82:83]
  s_waitcnt lgkmcnt(1)
  v_pk_add_f32 v[52:53], v[52:53], v[84:85]
  v_pk_add_f32 v[54:55], v[54:55], v[86:87]
  s_waitcnt lgkmcnt(0)
  v_pk_add_f32 v[56:57], v[56:57], v[88:89]
  v_pk_add_f32 v[58:59], v[58:59], v[90:91]
  v_cvt_pk_bf16_f32 v12, v44, v45
  v_cvt_pk_bf16_f32 v13, v46, v47
  v_cvt_pk_bf16_f32 v14, v48, v49
  v_cvt_pk_bf16_f32 v15, v50, v51
  v_cvt_pk_bf16_f32 v16, v52, v53
  v_cvt_pk_bf16_f32 v17, v54, v55
  v_cvt_pk_bf16_f32 v18, v56, v57
  v_cvt_pk_bf16_f32 v19, v58, v59
  s_cmp_eq_u32 s96, 0
  s_cbranch_scc1 Lfar18
  buffer_store_dwordx4 v[12:15], v2, s[32:35], s48 offen
  buffer_store_dwordx4 v[16:19], v2, s[32:35], s48 offen offset:1024
Lback19:
  v_pk_mul_f32 v[92:93], v[44:45], v[44:45]
  v_pk_add_f32 v[94:95], v[44:45], v[46:47]
  v_pk_fma_f32 v[92:93], v[46:47], v[46:47], v[92:93]
  v_pk_fma_f32 v[92:93], v[48:49], v[48:49], v[92:93]
  v_pk_add_f32 v[94:95], v[94:95], v[48:49]
  v_pk_fma_f32 v[92:93], v[50:51], v[50:51], v[92:93]
  v_pk_add_f32 v[94:95], v[94:95], v[50:51]
  v_pk_fma_f32 v[92:93], v[52:53], v[52:53], v[92:93]
  v_pk_add_f32 v[94:95], v[94:95], v[52:53]
  v_pk_fma_f32 v[92:93], v[54:55], v[54:55], v[92:93]
  v_pk_add_f32 v[94:95], v[94:95], v[54:55]
  v_pk_fma_f32 v[92:93], v[56:57], v[56:57], v[92:93]
  v_pk_add_f32 v[94:95], v[94:95], v[56:57]
  v_pk_fma_f32 v[92:93], v[58:59], v[58:59], v[92:93]
  v_pk_add_f32 v[94:95], v[94:95], v[58:59]
  v_add_f32 v92, v92, v93
  v_add_f32 v94, v94, v95
  s_nop 1
  v_permlane32_swap_b32 v94, v92
  v_add_f32_e64 v92, v92, v94
  s_cmp_eq_u32 s96, 0
  s_cbranch_scc1 Lfar20
  buffer_store_dword v92, v2, s[32:35], s49 offen
Lback21:
  v_bfe_u32 v20, v1, 2, 2
  v_bfe_u32 v21, v1, 4, 1
  v_bfe_u32 v22, v1, 1, 1
  v_and_b32 v23, 2, v20
  v_xor_b32 v22, v22, v23
  v_lshlrev_b32 v23, 2, v21
  v_xor_b32 v22, v22, v23
  v_lshlrev_b32 v22, 4, v22
  v_and_b32 v23, 1, v1
  v_lshl_add_u32 v22, v23, 3, v22
  v_lshl_add_u32 v22, v21, 13, v22
  v_lshrrev_b32_e64 v23, 5, v1
  v_lshl_add_u32 v20, v23, 4, v20
  v_lshl_add_u32 v204, v20, 7, v22
  v_xor_b32 v205, 32, v204
  v_xor_b32 v206, 64, v204
  v_xor_b32 v207, 96, v204
  v_add_u32 v208, 65536, v204
  s_add_u32 m0, s66, 32768
  s_add_u32 s62, s98, 1605632
  buffer_load_dwordx4 v7, s[16:19], s62 offen offset:0 lds
  v_add_u32 v209, 65536, v205
  v_add_u32 v210, 65536, v206
  v_add_u32 v211, 65536, v207
  v_add_u32 v212, 131072, v204
  v_add_u32 v213, 131072, v205
  v_add_u32 v214, 131072, v206
  v_add_u32 v215, 131072, v207
  v_lshlrev_b32 v32, 5, v1
  s_lshl_b32 s51, s41, 2
  s_add_u32 s51, s51, s40
  s_lshl_b32 s58, s51, 7
  s_lshl_b32 s20, s51, 15
  s_lshl_b32 s48, s22, 14
  s_sub_u32 s99, s20, s48
  s_add_u32 s20, s20, s48
  s_lshl_b32 s54, s51, 12
  s_add_u32 s54, s54, 262144
  s_mul_i32 s55, s51, 114688
  s_lshl_b32 s48, s42, 13
  s_add_u32 s55, s55, s48
  s_add_u32 s55, s55, 5242880
  s_lshl_b32 s56, s41, 10
  buffer_load_dwordx4 v8, s[16:19], s62 offen offset:1024 lds
  s_lshl_b32 s48, s40, 7
  s_add_u32 s56, s56, s48
  s_lshl_b32 s48, s42, 2
  s_add_u32 s56, s56, s48
  s_mul_i32 s21, s68, 114688
  s_mul_i32 s48, s47, 57344
  s_add_u32 s21, s21, s48
  s_lshl_b32 s57, s41, 10
  s_and_b32 s48, s68, 3
  s_lshl_b32 s48, s48, 7
  s_add_u32 s57, s57, s48
  s_mul_i32 s48, s47, 28
  s_add_u32 s57, s57, s48
  s_lshl_b32 s52, s68, 7
  s_lshl_b32 s51, s44, 3
  s_add_u32 s52, s52, s51
  s_lshl_b32 s51, s47, 2
  s_add_u32 s52, s52, s51
  s_add_u32 s52, s52, 8192
  buffer_load_dwordx4 v9, s[16:19], s62 offen offset:2048 lds
  buffer_load_dwordx4 v10, s[16:19], s62 offen offset:3072 lds
  s_waitcnt vmcnt(4)
  s_mov_b64 exec, 1
  s_add_u32 s53, s52, 65536
  s_cmp_eq_u32 s96, 0
  s_cbranch_scc1 Lfar22
  buffer_store_dword v251, off, s[32:35], s53
Lback23:
  s_mov_b64 exec, -1
  s_cmp_ge_u32 s42, 14
  s_cbranch_scc1 Lspare
  s_add_u32 s38, s58, 73728
  buffer_load_dword v255, v253, s[32:35], s38 offen sc1
  s_barrier
  ds_read_b64_tr_b16 v[172:173], v208 offset:0
  ds_read_b64_tr_b16 v[174:175], v208 offset:512
  ds_read_b64_tr_b16 v[176:177], v209 offset:0
  ds_read_b64_tr_b16 v[178:179], v209 offset:512
  ds_read_b64_tr_b16 v[180:181], v210 offset:0
  ds_read_b64_tr_b16 v[182:183], v210 offset:512
  ds_read_b64_tr_b16 v[184:185], v211 offset:0
  ds_read_b64_tr_b16 v[186:187], v211 offset:512
  s_mov_b32 s59, 0
  s_waitcnt vmcnt(0)
  v_cmp_ne_u32 vcc, s45, v255
  s_nop 0
  s_cbranch_vccnz Lpoll26
Lpdone27:
  s_add_u32 s63, s20, 3145728
  buffer_load_dwordx4 a[0:3], v2, s[32:35], s63 offen offset:0 sc1
  buffer_load_dwordx4 a[4:7], v2, s[32:35], s63 offen offset:1024 sc1
  buffer_load_dwordx4 a[8:11], v2, s[32:35], s63 offen offset:2048 sc1
  buffer_load_dwordx4 a[12:15], v2, s[32:35], s63 offen offset:3072 sc1
  s_add_u32 s63, s20, 3149824
  buffer_load_dwordx4 a[16:19], v2, s[32:35], s63 offen offset:0 sc1
  buffer_load_dwordx4 a[20:23], v2, s[32:35], s63 offen offset:1024 sc1
  s_waitcnt vmcnt(5) lgkmcnt(4)
  v_mfma_f32_32x32x16_bf16 v[44:59], v[172:175], a[0:3], 0
  ds_read_b64_tr_b16 v[188:189], v208 offset:1024
  ds_read_b64_tr_b16 v[190:191], v208 offset:1536
  v_mfma_f32_32x32x16_bf16 v[60:75], v[176:179], a[0:3], 0
  ds_read_b64_tr_b16 v[192:193], v209 offset:1024
  ds_read_b64_tr_b16 v[194:195], v209 offset:1536
  buffer_load_dwordx4 v[234:237], v2, s[32:35], s54 offen offset:0 sc1
  s_waitcnt lgkmcnt(4)
  v_mfma_f32_32x32x16_bf16 v[76:91], v[180:183], a[0:3], 0
  ds_read_b64_tr_b16 v[196:197], v210 offset:1024
  ds_read_b64_tr_b16 v[198:199], v210 offset:1536
  v_mfma_f32_32x32x16_bf16 v[92:107], v[184:187], a[0:3], 0
  ds_read_b64_tr_b16 v[200:201], v211 offset:1024
  ds_read_b64_tr_b16 v[202:203], v211 offset:1536
  buffer_load_dwordx4 a[24:27], v2, s[32:35], s63 offen offset:2048 sc1
  s_waitcnt vmcnt(6) lgkmcnt(4)
  v_mfma_f32_32x32x16_bf16 v[44:59], v[188:191], a[4:7], v[44:59]
  ds_read_b64_tr_b16 v[172:173], v208 offset:4096
  ds_read_b64_tr_b16 v[174:175], v208 offset:4608
  v_mfma_f32_32x32x16_bf16 v[60:75], v[192:195], a[4:7], v[60:75]
  ds_read_b64_tr_b16 v[176:177], v209 offset:4096
  ds_read_b64_tr_b16 v[178:179], v209 offset:4608
  buffer_load_dwordx4 v[238:241], v2, s[32:35], s54 offen offset:1024 sc1
  s_waitcnt lgkmcnt(4)
  v_mfma_f32_32x32x16_bf16 v[76:91], v[196:199], a[4:7], v[76:91]
  ds_read_b64_tr_b16 v[180:181], v210 offset:4096
  ds_read_b64_tr_b16 v[182:183], v210 offset:4608
  v_mfma_f32_32x32x16_bf16 v[92:107], v[200:203], a[4:7], v[92:107]
  ds_read_b64_tr_b16 v[184:185], v211 offset:4096
  ds_read_b64_tr_b16 v[186:187], v211 offset:4608
  buffer_load_dwordx4 a[28:31], v2, s[32:35], s63 offen offset:3072 sc1
  s_waitcnt vmcnt(7) lgkmcnt(4)
  v_mfma_f32_32x32x16_bf16 v[44:59], v[172:175], a[8:11], v[44:59]
  ds_read_b64_tr_b16 v[188:189], v208 offset:5120
  ds_read_b64_tr_b16 v[190:191], v208 offset:5632
  v_mfma_f32_32x32x16_bf16 v[60:75], v[176:179], a[8:11], v[60:75]
  ds_read_b64_tr_b16 v[192:193], v209 offset:5120
  ds_read_b64_tr_b16 v[194:195], v209 offset:5632
  buffer_load_dwordx4 v[242:245], v2, s[32:35], s54 offen offset:2048 sc1
  s_waitcnt lgkmcnt(4)
  v_mfma_f32_32x32x16_bf16 v[76:91], v[180:183], a[8:11], v[76:91]
  ds_read_b64_tr_b16 v[196:197], v210 offset:5120
  ds_read_b64_tr_b16 v[198:199], v210 offset:5632
  v_mfma_f32_32x32x16_bf16 v[92:107], v[184:187], a[8:11], v[92:107]
  ds_read_b64_tr_b16 v[200:201], v211 offset:5120
  ds_read_b64_tr_b16 v[202:203], v211 offset:5632
  s_add_u32 s63, s20, 3153920
  buffer_load_dwordx4 a[32:35], v2, s[32:35], s63 offen offset:0 sc1
  s_waitcnt vmcnt(8) lgkmcnt(4)
  v_mfma_f32_32x32x16_bf16 v[44:59], v[188:191], a[12:15], v[44:59]
  ds_read_b64_tr_b16 v[172:173], v208 offset:16384
  ds_read_b64_tr_b16 v[174:175], v208 offset:16896
  v_mfma_f32_32x32x16_bf16 v[60:75], v[192:195], a[12:15], v[60:75]
  ds_read_b64_tr_b16 v[176:177], v209 offset:16384
  ds_read_b64_tr_b16 v[178:179], v209 offset:16896
  buffer_load_dwordx4 v[246:249], v2, s[32:35], s54 offen offset:3072 sc1
  s_waitcnt lgkmcnt(4)
  v_mfma_f32_32x32x16_bf16 v[76:91], v[196:199], a[12:15], v[76:91]
  ds_read_b64_tr_b16 v[180:181], v210 offset:16384
  ds_read_b64_tr_b16 v[182:183], v210 offset:16896
  v_mfma_f32_32x32x16_bf16 v[92:107], v[200:203], a[12:15], v[92:107]
  ds_read_b64_tr_b16 v[184:185], v211 offset:16384
  ds_read_b64_tr_b16 v[186:187], v211 offset:16896
  buffer_load_dwordx4 a[36:39], v2, s[32:35], s63 offen offset:1024 sc1
  s_waitcnt vmcnt(9) lgkmcnt(4)
  v_mfma_f32_32x32x16_bf16 v[44:59], v[172:175], a[16:19], v[44:59]
  ds_read_b64_tr_b16 v[188:189], v208 offset:17408
  ds_read_b64_tr_b16 v[190:191], v208 offset:17920
  v_mfma_f32_32x32x16_bf16 v[60:75], v[176:179], a[16:19], v[60:75]
  ds_read_b64_tr_b16 v[192:193], v209 offset:17408
  ds_read_b64_tr_b16 v[194:195], v209 offset:17920
  buffer_load_dwordx4 a[40:43], v2, s[32:35], s63 offen offset:2048 sc1
  s_waitcnt lgkmcnt(4)
  v_mfma_f32_32x32x16_bf16 v[76:91], v[180:183], a[16:19], v[76:91]
  ds_read_b64_tr_b16 v[196:197], v210 offset:17408
  ds_read_b64_tr_b16 v[198:199], v210 offset:17920
  v_mfma_f32_32x32x16_bf16 v[92:107], v[184:187], a[16:19], v[92:107]
  ds_read_b64_tr_b16 v[200:201], v211 offset:17408
  ds_read_b64_tr_b16 v[202:203], v211 offset:17920
  buffer_load_dwordx4 a[44:47], v2, s[32:35], s63 offen offset:3072 sc1
  s_waitcnt vmcnt(10) lgkmcnt(4)
  v_mfma_f32_32x32x16_bf16 v[44:59], v[188:191], a[20:23], v[44:59]
  ds_read_b64_tr_b16 v[172:173], v208 offset:20480
  ds_read_b64_tr_b16 v[174:175], v208 offset:20992
  v_mfma_f32_32x32x16_bf16 v[60:75], v[192:195], a[20:23], v[60:75]
  ds_read_b64_tr_b16 v[176:177], v209 offset:20480
  ds_read_b64_tr_b16 v[178:179], v209 offset:20992
  s_add_u32 s63, s20, 3158016
  buffer_load_dwordx4 a[48:51], v2, s[32:35], s63 offen offset:0 sc1
  s_waitcnt lgkmcnt(4)
  v_mfma_f32_32x32x16_bf16 v[76:91], v[196:199], a[20:23], v[76:91]
  ds_read_b64_tr_b16 v[180:181], v210 offset:20480
  ds_read_b64_tr_b16 v[182:183], v210 offset:20992
  v_mfma_f32_32x32x16_bf16 v[92:107], v[200:203], a[20:23], v[92:107]
  ds_read_b64_tr_b16 v[184:185], v211 offset:20480
  ds_read_b64_tr_b16 v[186:187], v211 offset:20992
  buffer_load_dwordx4 a[52:55], v2, s[32:35], s63 offen offset:1024 sc1
  s_waitcnt vmcnt(10) lgkmcnt(4)
  v_mfma_f32_32x32x16_bf16 v[44:59], v[172:175], a[24:27], v[44:59]
  ds_read_b64_tr_b16 v[188:189], v208 offset:21504
  ds_read_b64_tr_b16 v[190:191], v208 offset:22016
  ds_read_b64_tr_b16 v[192:193], v209 offset:21504
  ds_read_b64_tr_b16 v[194:195], v209 offset:22016
  v_mfma_f32_32x32x16_bf16 v[60:75], v[176:179], a[24:27], v[60:75]
  ds_read_b64_tr_b16 v[196:197], v210 offset:21504
  ds_read_b64_tr_b16 v[198:199], v210 offset:22016
  ds_read_b64_tr_b16 v[200:201], v211 offset:21504
  ds_read_b64_tr_b16 v[202:203], v211 offset:22016
  s_waitcnt lgkmcnt(8)
  v_mfma_f32_32x32x16_bf16 v[76:91], v[180:183], a[24:27], v[76:91]
  buffer_load_dwordx4 a[56:59], v2, s[32:35], s63 offen offset:2048 sc1
  v_mfma_f32_32x32x16_bf16 v[92:107], v[184:187], a[24:27], v[92:107]
  buffer_load_dwordx4 a[60:63], v2, s[32:35], s63 offen offset:3072 sc1
  s_waitcnt lgkmcnt(0)
  s_waitcnt vmcnt(10)
  v_mfma_f32_32x32x16_bf16 v[44:59], v[188:191], a[28:31], v[44:59]
  s_barrier
  v_mfma_f32_32x32x16_bf16 v[60:75], v[192:195], a[28:31], v[60:75]
  ds_read_b64_tr_b16 v[172:173], v208 offset:32768
  ds_read_b64_tr_b16 v[174:175], v208 offset:33280
  ds_read_b64_tr_b16 v[176:177], v209 offset:32768
  s_add_u32 m0, s66, 65536
  s_add_u32 s62, s67, 128
  buffer_load_dwordx4 v7, s[16:19], s62 offen offset:0 lds
  v_mfma_f32_32x32x16_bf16 v[76:91], v[196:199], a[28:31], v[76:91]
  ds_read_b64_tr_b16 v[178:179], v209 offset:33280
  ds_read_b64_tr_b16 v[180:181], v210 offset:32768
  ds_read_b64_tr_b16 v[182:183], v210 offset:33280
  v_mfma_f32_32x32x16_bf16 v[92:107], v[200:203], a[28:31], v[92:107]
  ds_read_b64_tr_b16 v[184:185], v211 offset:32768
  ds_read_b64_tr_b16 v[186:187], v211 offset:33280
  s_add_u32 s63, s99, 3162112
  buffer_load_dwordx4 a[64:67], v2, s[32:35], s63 offen offset:0 sc1
  s_waitcnt vmcnt(10) lgkmcnt(4)
  v_mfma_f32_32x32x16_bf16 v[44:59], v[172:175], a[32:35], v[44:59]
  ds_read_b64_tr_b16 v[188:189], v208 offset:33792
  ds_read_b64_tr_b16 v[190:191], v208 offset:34304
  v_mfma_f32_32x32x16_bf16 v[60:75], v[176:179], a[32:35], v[60:75]
  ds_read_b64_tr_b16 v[192:193], v209 offset:33792
  ds_read_b64_tr_b16 v[194:195], v209 offset:34304
  buffer_load_dwordx4 v8, s[16:19], s62 offen offset:1024 lds
  s_waitcnt lgkmcnt(4)
  v_mfma_f32_32x32x16_bf16 v[76:91], v[180:183], a[32:35], v[76:91]
  ds_read_b64_tr_b16 v[196:197], v210 offset:33792
  ds_read_b64_tr_b16 v[198:199], v210 offset:34304
  v_mfma_f32_32x32x16_bf16 v[92:107], v[184:187], a[32:35], v[92:107]
  ds_read_b64_tr_b16 v[200:201], v211 offset:33792
  ds_read_b64_tr_b16 v[202:203], v211 offset:34304
  buffer_load_dwordx4 a[68:71], v2, s[32:35], s63 offen offset:1024 sc1
  s_waitcnt vmcnt(10) lgkmcnt(4)
  v_mfma_f32_32x32x16_bf16 v[44:59], v[188:191], a[36:39], v[44:59]
  ds_read_b64_tr_b16 v[172:173], v208 offset:36864
  ds_read_b64_tr_b16 v[174:175], v208 offset:37376
  v_mfma_f32_32x32x16_bf16 v[60:75], v[192:195], a[36:39], v[60:75]
  ds_read_b64_tr_b16 v[176:177], v209 offset:36864
  ds_read_b64_tr_b16 v[178:179], v209 offset:37376
  buffer_load_dwordx4 v9, s[16:19], s62 offen offset:2048 lds
  s_waitcnt lgkmcnt(4)
  v_mfma_f32_32x32x16_bf16 v[76:91], v[196:199], a[36:39], v[76:91]
  ds_read_b64_tr_b16 v[180:181], v210 offset:36864
  ds_read_b64_tr_b16 v[182:183], v210 offset:37376
  v_mfma_f32_32x32x16_bf16 v[92:107], v[200:203], a[36:39], v[92:107]
  ds_read_b64_tr_b16 v[184:185], v211 offset:36864
  ds_read_b64_tr_b16 v[186:187], v211 offset:37376
  buffer_load_dwordx4 a[72:75], v2, s[32:35], s63 offen offset:2048 sc1
  s_waitcnt vmcnt(11) lgkmcnt(4)
  v_mfma_f32_32x32x16_bf16 v[44:59], v[172:175], a[40:43], v[44:59]
  ds_read_b64_tr_b16 v[188:189], v208 offset:37888
  ds_read_b64_tr_b16 v[190:191], v208 offset:38400
  v_mfma_f32_32x32x16_bf16 v[60:75], v[176:179], a[40:43], v[60:75]
  ds_read_b64_tr_b16 v[192:193], v209 offset:37888
  ds_read_b64_tr_b16 v[194:195], v209 offset:38400
  buffer_load_dwordx4 v10, s[16:19], s62 offen offset:3072 lds
  s_waitcnt lgkmcnt(4)
  v_mfma_f32_32x32x16_bf16 v[76:91], v[180:183], a[40:43], v[76:91]
  ds_read_b64_tr_b16 v[196:197], v210 offset:37888
  ds_read_b64_tr_b16 v[198:199], v210 offset:38400
  v_mfma_f32_32x32x16_bf16 v[92:107], v[184:187], a[40:43], v[92:107]
  ds_read_b64_tr_b16 v[200:201], v211 offset:37888
  ds_read_b64_tr_b16 v[202:203], v211 offset:38400
  buffer_load_dwordx4 a[76:79], v2, s[32:35], s63 offen offset:3072 sc1
  s_waitcnt vmcnt(12) lgkmcnt(4)
  v_mfma_f32_32x32x16_bf16 v[44:59], v[188:191], a[44:47], v[44:59]
  ds_read_b64_tr_b16 v[172:173], v208 offset:49152
  ds_read_b64_tr_b16 v[174:175], v208 offset:49664
  v_mfma_f32_32x32x16_bf16 v[60:75], v[192:195], a[44:47], v[60:75]
  ds_read_b64_tr_b16 v[176:177], v209 offset:49152
  ds_read_b64_tr_b16 v[178:179], v209 offset:49664
  s_add_u32 m0, s66, 81920
  s_add_u32 s62, s67, 229504
  buffer_load_dwordx4 v7, s[16:19], s62 offen offset:0 lds
  s_waitcnt lgkmcnt(4)
  v_mfma_f32_32x32x16_bf16 v[76:91], v[196:199], a[44:47], v[76:91]
  ds_read_b64_tr_b16 v[180:181], v210 offset:49152
  ds_read_b64_tr_b16 v[182:183], v210 offset:49664
  v_mfma_f32_32x32x16_bf16 v[92:107], v[200:203], a[44:47], v[92:107]
  ds_read_b64_tr_b16 v[184:185], v211 offset:49152
  ds_read_b64_tr_b16 v[186:187], v211 offset:49664
  s_add_u32 s63, s99, 3166208
  buffer_load_dwordx4 a[80:83], v2, s[32:35], s63 offen offset:0 sc1
  s_waitcnt vmcnt(13) lgkmcnt(4)
  v_mfma_f32_32x32x16_bf16 v[44:59], v[172:175], a[48:51], v[44:59]
  ds_read_b64_tr_b16 v[188:189], v208 offset:50176
  ds_read_b64_tr_b16 v[190:191], v208 offset:50688
  v_mfma_f32_32x32x16_bf16 v[60:75], v[176:179], a[48:51], v[60:75]
  ds_read_b64_tr_b16 v[192:193], v209 offset:50176
  ds_read_b64_tr_b16 v[194:195], v209 offset:50688
  buffer_load_dwordx4 v8, s[16:19], s62 offen offset:1024 lds
  s_waitcnt lgkmcnt(4)
  v_mfma_f32_32x32x16_bf16 v[76:91], v[180:183], a[48:51], v[76:91]
  ds_read_b64_tr_b16 v[196:197], v210 offset:50176
  ds_read_b64_tr_b16 v[198:199], v210 offset:50688
  v_mfma_f32_32x32x16_bf16 v[92:107], v[184:187], a[48:51], v[92:107]
  ds_read_b64_tr_b16 v[200:201], v211 offset:50176
  ds_read_b64_tr_b16 v[202:203], v211 offset:50688
  buffer_load_dwordx4 a[84:87], v2, s[32:35], s63 offen offset:1024 sc1
  s_waitcnt vmcnt(14) lgkmcnt(4)
  v_mfma_f32_32x32x16_bf16 v[44:59], v[188:191], a[52:55], v[44:59]
  ds_read_b64_tr_b16 v[172:173], v208 offset:53248
  ds_read_b64_tr_b16 v[174:175], v208 offset:53760
  v_add_f32 v234, v234, v235
  v_add_f32 v236, v236, v237
  v_add_f32 v238, v238, v239
  v_mfma_f32_32x32x16_bf16 v[60:75], v[192:195], a[52:55], v[60:75]
  ds_read_b64_tr_b16 v[176:177], v209 offset:53248
  ds_read_b64_tr_b16 v[178:179], v209 offset:53760
  buffer_load_dwordx4 v9, s[16:19], s62 offen offset:2048 lds
  v_add_f32_e64 v240, v240, v241
  v_add_f32 v242, v242, v243
  s_waitcnt lgkmcnt(4)
  v_mfma_f32_32x32x16_bf16 v[76:91], v[196:199], a[52:55], v[76:91]
  ds_read_b64_tr_b16 v[180:181], v210 offset:53248
  ds_read_b64_tr_b16 v[182:183], v210 offset:53760
  v_add_f32 v244, v244, v245
  v_add_f32 v246, v246, v247
  v_add_f32_e64 v248, v248, v249
  v_mfma_f32_32x32x16_bf16 v[92:107], v[200:203], a[52:55], v[92:107]
  ds_read_b64_tr_b16 v[184:185], v211 offset:53248
  ds_read_b64_tr_b16 v[186:187], v211 offset:53760
  buffer_load_dwordx4 a[88:91], v2, s[32:35], s63 offen offset:2048 sc1
  v_add_f32_e64 v234, v234, v236
  v_add_f32 v238, v238, v240
  s_waitcnt vmcnt(15) lgkmcnt(4)
  v_mfma_f32_32x32x16_bf16 v[44:59], v[172:175], a[56:59], v[44:59]
  ds_read_b64_tr_b16 v[188:189], v208 offset:54272
  ds_read_b64_tr_b16 v[190:191], v208 offset:54784
  ds_read_b64_tr_b16 v[192:193], v209 offset:54272
  ds_read_b64_tr_b16 v[194:195], v209 offset:54784
  v_add_f32_e64 v242, v242, v244
  v_mfma_f32_32x32x16_bf16 v[60:75], v[176:179], a[56:59], v[60:75]
  ds_read_b64_tr_b16 v[196:197], v210 offset:54272
  ds_read_b64_tr_b16 v[198:199], v210 offset:54784
  ds_read_b64_tr_b16 v[200:201], v211 offset:54272
  ds_read_b64_tr_b16 v[202:203], v211 offset:54784
  v_add_f32 v246, v246, v248
  s_waitcnt lgkmcnt(8)
  v_mfma_f32_32x32x16_bf16 v[76:91], v[180:183], a[56:59], v[76:91]
  buffer_load_dwordx4 v10, s[16:19], s62 offen offset:3072 lds
  v_add_f32 v234, v234, v238
  v_add_f32 v242, v242, v246
  v_add_f32_e64 v234, v234, v242
  v_mul_f32 v234, 0x3b000000, v234
  v_mfma_f32_32x32x16_bf16 v[92:107], v[184:187], a[56:59], v[92:107]
  buffer_load_dwordx4 a[92:95], v2, s[32:35], s63 offen offset:3072 sc1
  v_mov_b32 v235, v234
  v_mov_b32 v236, 0
  v_cmp_gt_u32_e64 vcc, 32, v1
  v_permlane32_swap_b32 v234, v235
  s_waitcnt lgkmcnt(0)
  s_waitcnt vmcnt(16)
  v_mfma_f32_32x32x16_bf16 v[44:59], v[188:191], a[60:63], v[44:59]
  s_barrier
  v_mfma_f32_32x32x16_bf16 v[60:75], v[192:195], a[60:63], v[60:75]
  ds_read_b64_tr_b16 v[172:173], v212 offset:0
  ds_read_b64_tr_b16 v[174:175], v212 offset:512
  ds_read_b64_tr_b16 v[176:177], v213 offset:0
  s_add_u32 m0, s66, 98304
  s_add_u32 s62, s67, 458880
  buffer_load_dwordx4 v7, s[16:19], s62 offen offset:0 lds
  v_mfma_f32_32x32x16_bf16 v[76:91], v[196:199], a[60:63], v[76:91]
  ds_read_b64_tr_b16 v[178:179], v213 offset:512
  ds_read_b64_tr_b16 v[180:181], v214 offset:0
  ds_read_b64_tr_b16 v[182:183], v214 offset:512
  v_fma_f32 v235, -v234, v234, v235
  v_max_f32_e64 v235, 0, v235
  v_mfma_f32_32x32x16_bf16 v[92:107], v[200:203], a[60:63], v[92:107]
  ds_read_b64_tr_b16 v[184:185], v215 offset:0
  ds_read_b64_tr_b16 v[186:187], v215 offset:512
  s_add_u32 s63, s99, 3170304
  buffer_load_dwordx4 a[96:99], v2, s[32:35], s63 offen offset:0 sc1
  v_add_f32 v235, 0x3727c5ac, v235
  s_waitcnt vmcnt(16) lgkmcnt(4)
  v_mfma_f32_32x32x16_bf16 v[44:59], v[172:175], a[64:67], v[44:59]
  ds_read_b64_tr_b16 v[188:189], v212 offset:1024
  ds_read_b64_tr_b16 v[190:191], v212 offset:1536
  v_rcp_f32 v250, v235
  v_sub_f32_e64 v234, 0, v234
  v_mfma_f32_32x32x16_bf16 v[60:75], v[176:179], a[64:67], v[60:75]
  ds_read_b64_tr_b16 v[192:193], v213 offset:1024
  ds_read_b64_tr_b16 v[194:195], v213 offset:1536
  buffer_load_dwordx4 v8, s[16:19], s62 offen offset:1024 lds
  v_cvt_pk_bf16_f32 v237, v234, v234
  v_lshlrev_b32 v235, 16, v237
  s_waitcnt lgkmcnt(4)
  v_mfma_f32_32x32x16_bf16 v[76:91], v[180:183], a[64:67], v[76:91]
  ds_read_b64_tr_b16 v[196:197], v214 offset:1024
  ds_read_b64_tr_b16 v[198:199], v214 offset:1536
  v_sub_f32_e64 v235, v234, v235
  v_cvt_pk_bf16_f32 v238, v235, v236
  v_cndmask_b32_e64 v216, 0, v237, vcc
  v_mfma_f32_32x32x16_bf16 v[92:107], v[184:187], a[64:67], v[92:107]
  ds_read_b64_tr_b16 v[200:201], v215 offset:1024
  ds_read_b64_tr_b16 v[202:203], v215 offset:1536
  buffer_load_dwordx4 a[100:103], v2, s[32:35], s63 offen offset:1024 sc1
  v_cndmask_b32_e64 v217, 0, v238, vcc
  v_cndmask_b32 v218, v237, v236, vcc
  s_waitcnt vmcnt(16) lgkmcnt(4)
  v_mfma_f32_32x32x16_bf16 v[44:59], v[188:191], a[68:71], v[44:59]
  ds_read_b64_tr_b16 v[172:173], v212 offset:4096
  ds_read_b64_tr_b16 v[174:175], v212 offset:4608
  v_cndmask_b32_e64 v219, v238, v236, vcc
  v_mfma_f32_32x32x16_bf16 v[60:75], v[192:195], a[68:71], v[60:75]
  ds_read_b64_tr_b16 v[176:177], v213 offset:4096
  ds_read_b64_tr_b16 v[178:179], v213 offset:4608
  buffer_load_dwordx4 v9, s[16:19], s62 offen offset:2048 lds
  s_waitcnt lgkmcnt(4)
  v_mfma_f32_32x32x16_bf16 v[76:91], v[196:199], a[68:71], v[76:91]
  ds_read_b64_tr_b16 v[180:181], v214 offset:4096
  ds_read_b64_tr_b16 v[182:183], v214 offset:4608
  v_mfma_f32_32x32x16_bf16 v[92:107], v[200:203], a[68:71], v[92:107]
  ds_read_b64_tr_b16 v[184:185], v215 offset:4096
  ds_read_b64_tr_b16 v[186:187], v215 offset:4608
  buffer_load_dwordx4 a[104:107], v2, s[32:35], s63 offen offset:2048 sc1
  s_waitcnt vmcnt(16) lgkmcnt(4)
  v_mfma_f32_32x32x16_bf16 v[44:59], v[172:175], a[72:75], v[44:59]
  ds_read_b64_tr_b16 v[188:189], v212 offset:5120
  ds_read_b64_tr_b16 v[190:191], v212 offset:5632
  v_mfma_f32_32x32x16_bf16 v[60:75], v[176:179], a[72:75], v[60:75]
  ds_read_b64_tr_b16 v[192:193], v213 offset:5120
  ds_read_b64_tr_b16 v[194:195], v213 offset:5632
  buffer_load_dwordx4 v10, s[16:19], s62 offen offset:3072 lds
  s_waitcnt lgkmcnt(4)
  v_mfma_f32_32x32x16_bf16 v[76:91], v[180:183], a[72:75], v[76:91]
  ds_read_b64_tr_b16 v[196:197], v214 offset:5120
  ds_read_b64_tr_b16 v[198:199], v214 offset:5632
  v_mfma_f32_32x32x16_bf16 v[92:107], v[184:187], a[72:75], v[92:107]
  ds_read_b64_tr_b16 v[200:201], v215 offset:5120
  ds_read_b64_tr_b16 v[202:203], v215 offset:5632
  buffer_load_dwordx4 a[108:111], v2, s[32:35], s63 offen offset:3072 sc1
  s_waitcnt vmcnt(16) lgkmcnt(4)
  v_mfma_f32_32x32x16_bf16 v[44:59], v[188:191], a[76:79], v[44:59]
  ds_read_b64_tr_b16 v[172:173], v204 offset:0
  ds_read_b64_tr_b16 v[174:175], v204 offset:512
  v_mfma_f32_32x32x16_bf16 v[60:75], v[192:195], a[76:79], v[60:75]
  ds_read_b64_tr_b16 v[176:177], v205 offset:0
  ds_read_b64_tr_b16 v[178:179], v205 offset:512
  s_add_u32 m0, s66, 114688
  s_add_u32 s62, s67, 688256
  buffer_load_dwordx4 v7, s[16:19], s62 offen offset:0 lds
  s_waitcnt lgkmcnt(4)
  v_mfma_f32_32x32x16_bf16 v[76:91], v[196:199], a[76:79], v[76:91]
  ds_read_b64_tr_b16 v[180:181], v206 offset:0
  ds_read_b64_tr_b16 v[182:183], v206 offset:512
  v_mfma_f32_32x32x16_bf16 v[92:107], v[200:203], a[76:79], v[92:107]
  ds_read_b64_tr_b16 v[184:185], v207 offset:0
  ds_read_b64_tr_b16 v[186:187], v207 offset:512
  s_add_u32 s63, s99, 3174400
  buffer_load_dwordx4 a[112:115], v2, s[32:35], s63 offen offset:0 sc1
  s_waitcnt vmcnt(16) lgkmcnt(4)
  v_mfma_f32_32x32x16_bf16 v[44:59], v[172:175], a[80:83], v[44:59]
  ds_read_b64_tr_b16 v[188:189], v204 offset:1024
  ds_read_b64_tr_b16 v[190:191], v204 offset:1536
  v_mfma_f32_32x32x16_bf16 v[60:75], v[176:179], a[80:83], v[60:75]
  ds_read_b64_tr_b16 v[192:193], v205 offset:1024
  ds_read_b64_tr_b16 v[194:195], v205 offset:1536
  buffer_load_dwordx4 v8, s[16:19], s62 offen offset:1024 lds
  s_waitcnt lgkmcnt(4)
  v_mfma_f32_32x32x16_bf16 v[76:91], v[180:183], a[80:83], v[76:91]
  ds_read_b64_tr_b16 v[196:197], v206 offset:1024
  ds_read_b64_tr_b16 v[198:199], v206 offset:1536
  v_mfma_f32_32x32x16_bf16 v[92:107], v[184:187], a[80:83], v[92:107]
  ds_read_b64_tr_b16 v[200:201], v207 offset:1024
  ds_read_b64_tr_b16 v[202:203], v207 offset:1536
  buffer_load_dwordx4 a[116:119], v2, s[32:35], s63 offen offset:1024 sc1
  s_waitcnt vmcnt(16) lgkmcnt(4)
  v_mfma_f32_32x32x16_bf16 v[44:59], v[188:191], a[84:87], v[44:59]
  ds_read_b64_tr_b16 v[172:173], v204 offset:4096
  ds_read_b64_tr_b16 v[174:175], v204 offset:4608
  v_mfma_f32_32x32x16_bf16 v[60:75], v[192:195], a[84:87], v[60:75]
  ds_read_b64_tr_b16 v[176:177], v205 offset:4096
  ds_read_b64_tr_b16 v[178:179], v205 offset:4608
  buffer_load_dwordx4 v9, s[16:19], s62 offen offset:2048 lds
  s_waitcnt lgkmcnt(4)
  v_mfma_f32_32x32x16_bf16 v[76:91], v[196:199], a[84:87], v[76:91]
  ds_read_b64_tr_b16 v[180:181], v206 offset:4096
  ds_read_b64_tr_b16 v[182:183], v206 offset:4608
  v_mfma_f32_32x32x16_bf16 v[92:107], v[200:203], a[84:87], v[92:107]
  ds_read_b64_tr_b16 v[184:185], v207 offset:4096
  ds_read_b64_tr_b16 v[186:187], v207 offset:4608
  buffer_load_dwordx4 a[120:123], v2, s[32:35], s63 offen offset:2048 sc1
  s_waitcnt vmcnt(16) lgkmcnt(4)
  v_mfma_f32_32x32x16_bf16 v[44:59], v[172:175], a[88:91], v[44:59]
  ds_read_b64_tr_b16 v[188:189], v204 offset:5120
  ds_read_b64_tr_b16 v[190:191], v204 offset:5632
  ds_read_b64_tr_b16 v[192:193], v205 offset:5120
  ds_read_b64_tr_b16 v[194:195], v205 offset:5632
  v_mfma_f32_32x32x16_bf16 v[60:75], v[176:179], a[88:91], v[60:75]
  ds_read_b64_tr_b16 v[196:197], v206 offset:5120
  ds_read_b64_tr_b16 v[198:199], v206 offset:5632
  ds_read_b64_tr_b16 v[200:201], v207 offset:5120
  ds_read_b64_tr_b16 v[202:203], v207 offset:5632
  s_waitcnt lgkmcnt(8)
  v_mfma_f32_32x32x16_bf16 v[76:91], v[180:183], a[88:91], v[76:91]
  buffer_load_dwordx4 v10, s[16:19], s62 offen offset:3072 lds
  v_mfma_f32_32x32x16_bf16 v[92:107], v[184:187], a[88:91], v[92:107]
  buffer_load_dwordx4 a[124:127], v2, s[32:35], s63 offen offset:3072 sc1
  s_waitcnt lgkmcnt(0)
  s_waitcnt vmcnt(16)
  v_mfma_f32_32x32x16_bf16 v[44:59], v[188:191], a[92:95], v[44:59]
  s_barrier
  v_mfma_f32_32x32x16_bf16 v[60:75], v[192:195], a[92:95], v[60:75]
  ds_read_b64_tr_b16 v[172:173], v204 offset:16384
  ds_read_b64_tr_b16 v[174:175], v204 offset:16896
  ds_read_b64_tr_b16 v[176:177], v205 offset:16384
  s_add_u32 m0, s66, 131072
  s_add_u32 s62, s98, 917632
  buffer_load_dwordx4 v7, s[16:19], s62 offen offset:0 lds
  v_mfma_f32_32x32x16_bf16 v[76:91], v[196:199], a[92:95], v[76:91]
  ds_read_b64_tr_b16 v[178:179], v205 offset:16896
  ds_read_b64_tr_b16 v[180:181], v206 offset:16384
  ds_read_b64_tr_b16 v[182:183], v206 offset:16896
  v_mfma_f32_32x32x16_bf16 v[92:107], v[200:203], a[92:95], v[92:107]
  ds_read_b64_tr_b16 v[184:185], v207 offset:16384
  ds_read_b64_tr_b16 v[186:187], v207 offset:16896
  s_lshl_b32 s50, s42, 11
  s_add_u32 s50, s50, 196608
  buffer_load_dwordx4 v[220:223], v32, s[32:35], s50 offen offset:0 sc1
  s_waitcnt vmcnt(16) lgkmcnt(4)
  v_mfma_f32_32x32x16_bf16 v[44:59], v[172:175], a[96:99], v[44:59]
  ds_read_b64_tr_b16 v[188:189], v204 offset:17408
  ds_read_b64_tr_b16 v[190:191], v204 offset:17920
  v_mfma_f32_32x32x16_bf16 v[60:75], v[176:179], a[96:99], v[60:75]
  ds_read_b64_tr_b16 v[192:193], v205 offset:17408
  ds_read_b64_tr_b16 v[194:195], v205 offset:17920
  buffer_load_dwordx4 v8, s[16:19], s62 offen offset:1024 lds
  s_waitcnt lgkmcnt(4)
  v_mfma_f32_32x32x16_bf16 v[76:91], v[180:183], a[96:99], v[76:91]
  ds_read_b64_tr_b16 v[196:197], v206 offset:17408
  ds_read_b64_tr_b16 v[198:199], v206 offset:17920
  v_mfma_f32_32x32x16_bf16 v[92:107], v[184:187], a[96:99], v[92:107]
  ds_read_b64_tr_b16 v[200:201], v207 offset:17408
  ds_read_b64_tr_b16 v[202:203], v207 offset:17920
  buffer_load_dwordx4 v[224:227], v32, s[32:35], s50 offen offset:16 sc1
  s_waitcnt vmcnt(16) lgkmcnt(4)
  v_mfma_f32_32x32x16_bf16 v[44:59], v[188:191], a[100:103], v[44:59]
  ds_read_b64_tr_b16 v[172:173], v204 offset:20480
  ds_read_b64_tr_b16 v[174:175], v204 offset:20992
  v_mfma_f32_32x32x16_bf16 v[60:75], v[192:195], a[100:103], v[60:75]
  ds_read_b64_tr_b16 v[176:177], v205 offset:20480
  ds_read_b64_tr_b16 v[178:179], v205 offset:20992
  buffer_load_dwordx4 v9, s[16:19], s62 offen offset:2048 lds
  s_waitcnt lgkmcnt(4)
  v_mfma_f32_32x32x16_bf16 v[76:91], v[196:199], a[100:103], v[76:91]
  ds_read_b64_tr_b16 v[180:181], v206 offset:20480
  ds_read_b64_tr_b16 v[182:183], v206 offset:20992
  v_mfma_f32_32x32x16_bf16 v[92:107], v[200:203], a[100:103], v[92:107]
  ds_read_b64_tr_b16 v[184:185], v207 offset:20480
  ds_read_b64_tr_b16 v[186:187], v207 offset:20992
  s_add_u32 s50, s90, Lpc28-Lpc28
  s_min_u32 s50, s50, Lend-Lpc28
  s_getpc_b64 s[48:49]
Lpc28:
  s_add_u32 s48, s48, s50
  s_addc_u32 s49, s49, 0
  v_mov_b32_e64 v228, s48
  v_mov_b32 v229, s49
  s_mov_b64 exec, 1
  global_load_dword v230, v[228:229], off
  s_mov_b64 exec, -1
  s_waitcnt vmcnt(16) lgkmcnt(4)
  v_mfma_f32_32x32x16_bf16 v[44:59], v[172:175], a[104:107], v[44:59]
  ds_read_b64_tr_b16 v[188:189], v204 offset:21504
  ds_read_b64_tr_b16 v[190:191], v204 offset:22016
  v_mfma_f32_32x32x16_bf16 v[60:75], v[176:179], a[104:107], v[60:75]
  ds_read_b64_tr_b16 v[192:193], v205 offset:21504
  ds_read_b64_tr_b16 v[194:195], v205 offset:22016
  buffer_load_dwordx4 v10, s[16:19], s62 offen offset:3072 lds
  s_waitcnt lgkmcnt(4)
  v_mfma_f32_32x32x16_bf16 v[76:91], v[180:183], a[104:107], v[76:91]
  ds_read_b64_tr_b16 v[196:197], v206 offset:21504
  ds_read_b64_tr_b16 v[198:199], v206 offset:22016
  v_mfma_f32_32x32x16_bf16 v[92:107], v[184:187], a[104:107], v[92:107]
  ds_read_b64_tr_b16 v[200:201], v207 offset:21504
  ds_read_b64_tr_b16 v[202:203], v207 offset:22016
  s_waitcnt vmcnt(15) lgkmcnt(4)
  v_mfma_f32_32x32x16_bf16 v[44:59], v[188:191], a[108:111], v[44:59]
  ds_read_b64_tr_b16 v[172:173], v204 offset:32768
  ds_read_b64_tr_b16 v[174:175], v204 offset:33280
  v_mfma_f32_32x32x16_bf16 v[60:75], v[192:195], a[108:111], v[60:75]
  ds_read_b64_tr_b16 v[176:177], v205 offset:32768
  ds_read_b64_tr_b16 v[178:179], v205 offset:33280
  s_add_u32 m0, s66, 0
  s_add_u32 s62, s98, 1147008
  buffer_load_dwordx4 v7, s[16:19], s62 offen offset:0 lds
  s_waitcnt lgkmcnt(4)
  v_mfma_f32_32x32x16_bf16 v[76:91], v[196:199], a[108:111], v[76:91]
  ds_read_b64_tr_b16 v[180:181], v206 offset:32768
  ds_read_b64_tr_b16 v[182:183], v206 offset:33280
  v_mfma_f32_32x32x16_bf16 v[92:107], v[200:203], a[108:111], v[92:107]
  ds_read_b64_tr_b16 v[184:185], v207 offset:32768
  ds_read_b64_tr_b16 v[186:187], v207 offset:33280
  s_waitcnt vmcnt(14) lgkmcnt(4)
  v_mfma_f32_32x32x16_bf16 v[44:59], v[172:175], a[112:115], v[44:59]
  ds_read_b64_tr_b16 v[188:189], v204 offset:33792
  ds_read_b64_tr_b16 v[190:191], v204 offset:34304
  v_mfma_f32_32x32x16_bf16 v[60:75], v[176:179], a[112:115], v[60:75]
  ds_read_b64_tr_b16 v[192:193], v205 offset:33792
  ds_read_b64_tr_b16 v[194:195], v205 offset:34304
  buffer_load_dwordx4 v8, s[16:19], s62 offen offset:1024 lds
  s_waitcnt lgkmcnt(4)
  v_mfma_f32_32x32x16_bf16 v[76:91], v[180:183], a[112:115], v[76:91]
  ds_read_b64_tr_b16 v[196:197], v206 offset:33792
  ds_read_b64_tr_b16 v[198:199], v206 offset:34304
  v_mfma_f32_32x32x16_bf16 v[92:107], v[184:187], a[112:115], v[92:107]
  ds_read_b64_tr_b16 v[200:201], v207 offset:33792
  ds_read_b64_tr_b16 v[202:203], v207 offset:34304
  s_waitcnt vmcnt(13) lgkmcnt(4)
  v_mfma_f32_32x32x16_bf16 v[44:59], v[188:191], a[116:119], v[44:59]
  ds_read_b64_tr_b16 v[172:173], v204 offset:36864
  ds_read_b64_tr_b16 v[174:175], v204 offset:37376
  v_mfma_f32_32x32x16_bf16 v[60:75], v[192:195], a[116:119], v[60:75]
  ds_read_b64_tr_b16 v[176:177], v205 offset:36864
  ds_read_b64_tr_b16 v[178:179], v205 offset:37376
  buffer_load_dwordx4 v9, s[16:19], s62 offen offset:2048 lds
  s_waitcnt lgkmcnt(4)
  v_mfma_f32_32x32x16_bf16 v[76:91], v[196:199], a[116:119], v[76:91]
  ds_read_b64_tr_b16 v[180:181], v206 offset:36864
  ds_read_b64_tr_b16 v[182:183], v206 offset:37376
  v_mfma_f32_32x32x16_bf16 v[92:107], v[200:203], a[116:119], v[92:107]
  ds_read_b64_tr_b16 v[184:185], v207 offset:36864
  ds_read_b64_tr_b16 v[186:187], v207 offset:37376
  s_waitcnt vmcnt(12) lgkmcnt(4)
  v_mfma_f32_32x32x16_bf16 v[44:59], v[172:175], a[120:123], v[44:59]
  ds_read_b64_tr_b16 v[188:189], v204 offset:37888
  ds_read_b64_tr_b16 v[190:191], v204 offset:38400
  ds_read_b64_tr_b16 v[192:193], v205 offset:37888
  ds_read_b64_tr_b16 v[194:195], v205 offset:38400
  s_waitcnt vmcnt(6)
  v_mfma_f32_32x32x16_bf16 v[60:75], v[176:179], a[120:123], v[60:75]
  ds_read_b64_tr_b16 v[196:197], v206 offset:37888
  ds_read_b64_tr_b16 v[198:199], v206 offset:38400
  ds_read_b64_tr_b16 v[200:201], v207 offset:37888
  ds_read_b64_tr_b16 v[202:203], v207 offset:38400
  v_xor_b32 v234, s45, v221
  s_waitcnt lgkmcnt(8)
  v_mfma_f32_32x32x16_bf16 v[76:91], v[180:183], a[120:123], v[76:91]
  buffer_load_dwordx4 v10, s[16:19], s62 offen offset:3072 lds
  v_xor_b32 v235, s45, v223
  v_xor_b32 v236, s45, v225
  v_or3_b32 v234, v234, v235, v236
  v_xor_b32_e64 v235, s45, v227
  v_mfma_f32_32x32x16_bf16 v[92:107], v[184:187], a[120:123], v[92:107]
  s_add_u32 m0, s64, 49152
  s_add_u32 s62, s65, 0
  buffer_load_dwordx4 v3, s[24:27], s62 offen offset:0 lds
  v_or_b32 v234, v234, v235
  s_mov_b32 s59, 0
  v_cmp_ne_u32 vcc, 0, v234
  s_nop 0
  s_cbranch_vccnz Lsa29
Lsad30:
  s_waitcnt lgkmcnt(0)
  v_mfma_f32_32x32x16_bf16 v[44:59], v[188:191], a[124:127], v[44:59]
  s_barrier
  v_mfma_f32_32x32x16_bf16 v[60:75], v[192:195], a[124:127], v[60:75]
  ds_read_b64_tr_b16 v[172:173], v208 offset:0
  ds_read_b64_tr_b16 v[174:175], v208 offset:512
  ds_read_b64_tr_b16 v[176:177], v209 offset:0
  buffer_load_dwordx4 v4, s[24:27], s62 offen offset:1024 lds
  v_and_b32 v221, 0xffff, v220
  v_mfma_f32_32x32x16_bf16 v[76:91], v[196:199], a[124:127], v[76:91]
  ds_read_b64_tr_b16 v[178:179], v209 offset:512
  ds_read_b64_tr_b16 v[180:181], v210 offset:0
  ds_read_b64_tr_b16 v[182:183], v210 offset:512
  v_and_b32 v223, 0xffff, v222
  v_and_b32 v225, 0xffff, v224
  v_mfma_f32_32x32x16_bf16 v[92:107], v[200:203], a[124:127], v[92:107]
  ds_read_b64_tr_b16 v[184:185], v211 offset:0
  ds_read_b64_tr_b16 v[186:187], v211 offset:512
  buffer_load_dwordx4 v5, s[24:27], s62 offen offset:2048 lds
  v_and_b32 v227, 0xffff, v226
  v_mfma_f32_32x32x8_bf16 v[44:59], v[220:221], v[216:217], v[44:59]
  v_mfma_f32_32x32x8_bf16 v[60:75], v[222:223], v[216:217], v[60:75]
  v_mfma_f32_32x32x8_bf16 v[76:91], v[224:225], v[216:217], v[76:91]
  v_mfma_f32_32x32x8_bf16 v[92:107], v[226:227], v[216:217], v[92:107]
  s_waitcnt lgkmcnt(4)
  v_mfma_f32_32x32x16_bf16 v[108:123], v[172:175], a[0:3], 0
  ds_read_b64_tr_b16 v[188:189], v208 offset:1024
  ds_read_b64_tr_b16 v[190:191], v208 offset:1536
  s_nop 0
  s_nop 0
  s_nop 0
  v_mfma_f32_32x32x16_bf16 v[124:139], v[176:179], a[0:3], 0
  ds_read_b64_tr_b16 v[192:193], v209 offset:1024
  ds_read_b64_tr_b16 v[194:195], v209 offset:1536
  buffer_load_dwordx4 v6, s[24:27], s62 offen offset:3072 lds
  v_mul_f32_e64 v44, v44, v52
  v_mul_f32 v45, v45, v53
  s_waitcnt lgkmcnt(4)
  v_mfma_f32_32x32x16_bf16 v[140:155], v[180:183], a[0:3], 0
  ds_read_b64_tr_b16 v[196:197], v210 offset:1024
  ds_read_b64_tr_b16 v[198:199], v210 offset:1536
  v_mul_f32 v46, v46, v54
  v_mul_f32 v47, v47, v55
  v_mul_f32_e64 v48, v48, v56
  v_mfma_f32_32x32x16_bf16 v[156:171], v[184:187], a[0:3], 0
  ds_read_b64_tr_b16 v[200:201], v211 offset:1024
  ds_read_b64_tr_b16 v[202:203], v211 offset:1536
  s_add_u32 m0, s66, 16384
  s_add_u32 s62, s98, 1376384
  buffer_load_dwordx4 v7, s[16:19], s62 offen offset:0 lds
  s_waitcnt lgkmcnt(4)
  v_mfma_f32_32x32x16_bf16 v[108:123], v[188:191], a[4:7], v[108:123]
  ds_read_b64_tr_b16 v[172:173], v208 offset:4096
  ds_read_b64_tr_b16 v[174:175], v208 offset:4608
  v_mul_f32 v49, v49, v57
  v_mul_f32 v50, v50, v58
  v_mul_f32 v51, v51, v59
  v_mfma_f32_32x32x16_bf16 v[124:139], v[192:195], a[4:7], v[124:139]
  ds_read_b64_tr_b16 v[176:177], v209 offset:4096
  ds_read_b64_tr_b16 v[178:179], v209 offset:4608
  buffer_load_dwordx4 v8, s[16:19], s62 offen offset:1024 lds
  v_mul_f32_e64 v44, v250, v44
  v_mul_f32 v45, v250, v45
  s_waitcnt lgkmcnt(4)
  v_mfma_f32_32x32x16_bf16 v[140:155], v[196:199], a[4:7], v[140:155]
  ds_read_b64_tr_b16 v[180:181], v210 offset:4096
  ds_read_b64_tr_b16 v[182:183], v210 offset:4608
  v_mul_f32 v46, v250, v46
  v_mul_f32 v47, v250, v47
  v_mul_f32_e64 v48, v250, v48
  v_mfma_f32_32x32x16_bf16 v[156:171], v[200:203], a[4:7], v[156:171]
  ds_read_b64_tr_b16 v[184:185], v211 offset:4096
  ds_read_b64_tr_b16 v[186:187], v211 offset:4608
  v_mul_f32 v49, v250, v49
  v_mul_f32 v50, v250, v50
  v_mul_f32 v51, v250, v51
  s_waitcnt lgkmcnt(4)
  v_mfma_f32_32x32x16_bf16 v[108:123], v[172:175], a[8:11], v[108:123]
  ds_read_b64_tr_b16 v[188:189], v208 offset:5120
  ds_read_b64_tr_b16 v[190:191], v208 offset:5632
  v_cvt_pk_bf16_f32 v24, v44, v45
  v_cvt_pk_bf16_f32 v25, v46, v47
  v_cvt_pk_bf16_f32 v26, v48, v49
  v_mfma_f32_32x32x16_bf16 v[124:139], v[176:179], a[8:11], v[124:139]
  ds_read_b64_tr_b16 v[192:193], v209 offset:5120
  ds_read_b64_tr_b16 v[194:195], v209 offset:5632
  buffer_load_dwordx4 v9, s[16:19], s62 offen offset:2048 lds
  v_cvt_pk_bf16_f32 v27, v50, v51
  buffer_store_dwordx4 v[24:27], v2, s[32:35], s55 offen offset:0 sc1
  s_waitcnt lgkmcnt(4)
  v_mfma_f32_32x32x16_bf16 v[140:155], v[180:183], a[8:11], v[140:155]
  ds_read_b64_tr_b16 v[196:197], v210 offset:5120
  ds_read_b64_tr_b16 v[198:199], v210 offset:5632
  v_mul_f32 v60, v60, v68
  v_mul_f32 v61, v61, v69
  v_mul_f32 v62, v62, v70
  v_mfma_f32_32x32x16_bf16 v[156:171], v[184:187], a[8:11], v[156:171]
  ds_read_b64_tr_b16 v[200:201], v211 offset:5120
  ds_read_b64_tr_b16 v[202:203], v211 offset:5632
  v_mul_f32 v63, v63, v71
  v_mul_f32 v64, v64, v72
  v_mul_f32 v65, v65, v73
  s_waitcnt lgkmcnt(4)
  v_mfma_f32_32x32x16_bf16 v[108:123], v[188:191], a[12:15], v[108:123]
  ds_read_b64_tr_b16 v[172:173], v208 offset:16384
  ds_read_b64_tr_b16 v[174:175], v208 offset:16896
  v_mul_f32 v66, v66, v74
  v_mul_f32 v67, v67, v75
  v_mul_f32_e64 v60, v250, v60
  v_mfma_f32_32x32x16_bf16 v[124:139], v[192:195], a[12:15], v[124:139]
  ds_read_b64_tr_b16 v[176:177], v209 offset:16384
  ds_read_b64_tr_b16 v[178:179], v209 offset:16896
  buffer_load_dwordx4 v10, s[16:19], s62 offen offset:3072 lds
  v_mul_f32_e64 v61, v250, v61
  v_mul_f32 v62, v250, v62
  s_waitcnt lgkmcnt(4)
  v_mfma_f32_32x32x16_bf16 v[140:155], v[196:199], a[12:15], v[140:155]
  ds_read_b64_tr_b16 v[180:181], v210 offset:16384
  ds_read_b64_tr_b16 v[182:183], v210 offset:16896
  v_mul_f32 v63, v250, v63
  v_mul_f32 v64, v250, v64
  v_mul_f32_e64 v65, v250, v65
  v_mfma_f32_32x32x16_bf16 v[156:171], v[200:203], a[12:15], v[156:171]
  ds_read_b64_tr_b16 v[184:185], v211 offset:16384
  ds_read_b64_tr_b16 v[186:187], v211 offset:16896
  v_mul_f32_e64 v66, v250, v66
  v_mul_f32 v67, v250, v67
  v_cvt_pk_bf16_f32 v28, v60, v61
  s_waitcnt lgkmcnt(4)
  v_mfma_f32_32x32x16_bf16 v[108:123], v[172:175], a[16:19], v[108:123]
  ds_read_b64_tr_b16 v[188:189], v208 offset:17408
  ds_read_b64_tr_b16 v[190:191], v208 offset:17920
  v_cvt_pk_bf16_f32 v29, v62, v63
  v_cvt_pk_bf16_f32 v30, v64, v65
  v_cvt_pk_bf16_f32 v31, v66, v67
  v_mfma_f32_32x32x16_bf16 v[124:139], v[176:179], a[16:19], v[124:139]
  ds_read_b64_tr_b16 v[192:193], v209 offset:17408
  ds_read_b64_tr_b16 v[194:195], v209 offset:17920
  s_add_u32 m0, s66, 32768
  s_add_u32 s62, s98, 1605760
  buffer_load_dwordx4 v7, s[16:19], s62 offen offset:0 lds
  s_waitcnt lgkmcnt(4)
  v_mfma_f32_32x32x16_bf16 v[140:155], v[180:183], a[16:19], v[140:155]
  ds_read_b64_tr_b16 v[196:197], v210 offset:17408
  ds_read_b64_tr_b16 v[198:199], v210 offset:17920
  buffer_store_dwordx4 v[28:31], v2, s[32:35], s55 offen offset:1024 sc1
  v_mul_f32 v76, v76, v84
  v_mul_f32_e64 v77, v77, v85
  v_mfma_f32_32x32x16_bf16 v[156:171], v[184:187], a[16:19], v[156:171]
  ds_read_b64_tr_b16 v[200:201], v211 offset:17408
  ds_read_b64_tr_b16 v[202:203], v211 offset:17920
  v_mul_f32 v78, v78, v86
  v_mul_f32 v79, v79, v87
  v_mul_f32 v80, v80, v88
  s_waitcnt lgkmcnt(4)
  v_mfma_f32_32x32x16_bf16 v[108:123], v[188:191], a[20:23], v[108:123]
  ds_read_b64_tr_b16 v[172:173], v208 offset:20480
  ds_read_b64_tr_b16 v[174:175], v208 offset:20992
  v_mul_f32 v81, v81, v89
  v_mul_f32 v82, v82, v90
  v_mul_f32_e64 v83, v83, v91
  v_mfma_f32_32x32x16_bf16 v[124:139], v[192:195], a[20:23], v[124:139]
  ds_read_b64_tr_b16 v[176:177], v209 offset:20480
  ds_read_b64_tr_b16 v[178:179], v209 offset:20992
  buffer_load_dwordx4 v8, s[16:19], s62 offen offset:1024 lds
  v_mul_f32_e64 v76, v250, v76
  v_mul_f32 v77, v250, v77
  s_waitcnt lgkmcnt(4)
  v_mfma_f32_32x32x16_bf16 v[140:155], v[196:199], a[20:23], v[140:155]
  ds_read_b64_tr_b16 v[180:181], v210 offset:20480
  ds_read_b64_tr_b16 v[182:183], v210 offset:20992
  v_mul_f32 v78, v250, v78
  v_mul_f32 v79, v250, v79
  v_mul_f32_e64 v80, v250, v80
  v_mfma_f32_32x32x16_bf16 v[156:171], v[200:203], a[20:23], v[156:171]
  ds_read_b64_tr_b16 v[184:185], v211 offset:20480
  ds_read_b64_tr_b16 v[186:187], v211 offset:20992
  v_mul_f32 v81, v250, v81
  v_mul_f32 v82, v250, v82
  v_mul_f32 v83, v250, v83
  s_waitcnt lgkmcnt(4)
  v_mfma_f32_32x32x16_bf16 v[108:123], v[172:175], a[24:27], v[108:123]
  ds_read_b64_tr_b16 v[188:189], v208 offset:21504
  ds_read_b64_tr_b16 v[190:191], v208 offset:22016
  ds_read_b64_tr_b16 v[192:193], v209 offset:21504
  ds_read_b64_tr_b16 v[194:195], v209 offset:22016
  v_cvt_pk_bf16_f32 v24, v76, v77
  v_mfma_f32_32x32x16_bf16 v[124:139], v[176:179], a[24:27], v[124:139]
  ds_read_b64_tr_b16 v[196:197], v210 offset:21504
  ds_read_b64_tr_b16 v[198:199], v210 offset:22016
  ds_read_b64_tr_b16 v[200:201], v211 offset:21504
  ds_read_b64_tr_b16 v[202:203], v211 offset:22016
  v_cvt_pk_bf16_f32 v25, v78, v79
  s_waitcnt lgkmcnt(8)
  v_mfma_f32_32x32x16_bf16 v[140:155], v[180:183], a[24:27], v[140:155]
  buffer_load_dwordx4 v9, s[16:19], s62 offen offset:2048 lds
  v_cvt_pk_bf16_f32 v26, v80, v81
  v_cvt_pk_bf16_f32 v27, v82, v83
  buffer_store_dwordx4 v[24:27], v2, s[32:35], s55 offen offset:2048 sc1
  v_mul_f32 v92, v92, v100
  v_mfma_f32_32x32x16_bf16 v[156:171], v[184:187], a[24:27], v[156:171]
  v_mul_f32 v93, v93, v101
  v_mul_f32 v94, v94, v102
  v_mul_f32 v95, v95, v103
  v_mul_f32 v96, v96, v104
  v_mul_f32_e64 v97, v97, v105
  s_waitcnt lgkmcnt(0)
  v_mfma_f32_32x32x16_bf16 v[108:123], v[188:191], a[28:31], v[108:123]
  s_barrier
  v_mfma_f32_32x32x16_bf16 v[124:139], v[192:195], a[28:31], v[124:139]
  ds_read_b64_tr_b16 v[172:173], v208 offset:32768
  ds_read_b64_tr_b16 v[174:175], v208 offset:33280
  ds_read_b64_tr_b16 v[176:177], v209 offset:32768
  buffer_load_dwordx4 v10, s[16:19], s62 offen offset:3072 lds
  v_mul_f32_e64 v98, v98, v106
  v_mfma_f32_32x32x16_bf16 v[140:155], v[196:199], a[28:31], v[140:155]
  ds_read_b64_tr_b16 v[178:179], v209 offset:33280
  ds_read_b64_tr_b16 v[180:181], v210 offset:32768
  ds_read_b64_tr_b16 v[182:183], v210 offset:33280
  v_mul_f32 v99, v99, v107
  v_mul_f32 v92, v250, v92
  v_mfma_f32_32x32x16_bf16 v[156:171], v[200:203], a[28:31], v[156:171]
  ds_read_b64_tr_b16 v[184:185], v211 offset:32768
  ds_read_b64_tr_b16 v[186:187], v211 offset:33280
  s_add_u32 m0, s64, 147456
  s_add_u32 s62, s65, 131072
  buffer_load_dwordx4 v3, s[24:27], s62 offen offset:0 lds
  s_waitcnt lgkmcnt(4)
  v_mfma_f32_32x32x16_bf16 v[108:123], v[172:175], a[32:35], v[108:123]
  ds_read_b64_tr_b16 v[188:189], v208 offset:33792
  ds_read_b64_tr_b16 v[190:191], v208 offset:34304
  v_mul_f32 v93, v250, v93
  v_mul_f32 v94, v250, v94
  v_mul_f32 v95, v250, v95
  v_mfma_f32_32x32x16_bf16 v[124:139], v[176:179], a[32:35], v[124:139]
  ds_read_b64_tr_b16 v[192:193], v209 offset:33792
  ds_read_b64_tr_b16 v[194:195], v209 offset:34304
  buffer_load_dwordx4 v4, s[24:27], s62 offen offset:1024 lds
  v_mul_f32_e64 v96, v250, v96
  v_mul_f32 v97, v250, v97
  s_waitcnt lgkmcnt(4)
  v_mfma_f32_32x32x16_bf16 v[140:155], v[180:183], a[32:35], v[140:155]
  ds_read_b64_tr_b16 v[196:197], v210 offset:33792
  ds_read_b64_tr_b16 v[198:199], v210 offset:34304
  v_mul_f32_e64 v98, v250, v98
  v_mul_f32 v99, v250, v99
  v_cvt_pk_bf16_f32 v28, v92, v93
  v_mfma_f32_32x32x16_bf16 v[156:171], v[184:187], a[32:35], v[156:171]
  ds_read_b64_tr_b16 v[200:201], v211 offset:33792
  ds_read_b64_tr_b16 v[202:203], v211 offset:34304
  buffer_load_dwordx4 v5, s[24:27], s62 offen offset:2048 lds
  v_cvt_pk_bf16_f32 v29, v94, v95
  v_cvt_pk_bf16_f32 v30, v96, v97
  s_waitcnt lgkmcnt(4)
  v_mfma_f32_32x32x16_bf16 v[108:123], v[188:191], a[36:39], v[108:123]
  ds_read_b64_tr_b16 v[172:173], v208 offset:36864
  ds_read_b64_tr_b16 v[174:175], v208 offset:37376
  v_cvt_pk_bf16_f32 v31, v98, v99
  buffer_store_dwordx4 v[28:31], v2, s[32:35], s55 offen offset:3072 sc1
  v_mfma_f32_32x32x16_bf16 v[124:139], v[192:195], a[36:39], v[124:139]
  ds_read_b64_tr_b16 v[176:177], v209 offset:36864
  ds_read_b64_tr_b16 v[178:179], v209 offset:37376
  buffer_load_dwordx4 v6, s[24:27], s62 offen offset:3072 lds
  s_waitcnt lgkmcnt(4)
  v_mfma_f32_32x32x16_bf16 v[140:155], v[196:199], a[36:39], v[140:155]
  ds_read_b64_tr_b16 v[180:181], v210 offset:36864
  ds_read_b64_tr_b16 v[182:183], v210 offset:37376
  v_mfma_f32_32x32x16_bf16 v[156:171], v[200:203], a[36:39], v[156:171]
  ds_read_b64_tr_b16 v[184:185], v211 offset:36864
  ds_read_b64_tr_b16 v[186:187], v211 offset:37376
  s_add_u32 m0, s64, 65536
  s_add_u32 s62, s65, 262144
  buffer_load_dwordx4 v3, s[24:27], s62 offen offset:0 lds
  s_waitcnt lgkmcnt(4)
  v_mfma_f32_32x32x16_bf16 v[108:123], v[172:175], a[40:43], v[108:123]
  ds_read_b64_tr_b16 v[188:189], v208 offset:37888
  ds_read_b64_tr_b16 v[190:191], v208 offset:38400
  v_mfma_f32_32x32x16_bf16 v[124:139], v[176:179], a[40:43], v[124:139]
  ds_read_b64_tr_b16 v[192:193], v209 offset:37888
  ds_read_b64_tr_b16 v[194:195], v209 offset:38400
  buffer_load_dwordx4 v4, s[24:27], s62 offen offset:1024 lds
  s_waitcnt lgkmcnt(4)
  v_mfma_f32_32x32x16_bf16 v[140:155], v[180:183], a[40:43], v[140:155]
  ds_read_b64_tr_b16 v[196:197], v210 offset:37888
  ds_read_b64_tr_b16 v[198:199], v210 offset:38400
  v_mfma_f32_32x32x16_bf16 v[156:171], v[184:187], a[40:43], v[156:171]
  ds_read_b64_tr_b16 v[200:201], v211 offset:37888
  ds_read_b64_tr_b16 v[202:203], v211 offset:38400
  buffer_load_dwordx4 v5, s[24:27], s62 offen offset:2048 lds
  s_waitcnt lgkmcnt(4)
  v_mfma_f32_32x32x16_bf16 v[108:123], v[188:191], a[44:47], v[108:123]
  ds_read_b64_tr_b16 v[172:173], v208 offset:49152
  ds_read_b64_tr_b16 v[174:175], v208 offset:49664
  v_mfma_f32_32x32x16_bf16 v[124:139], v[192:195], a[44:47], v[124:139]
  ds_read_b64_tr_b16 v[176:177], v209 offset:49152
  ds_read_b64_tr_b16 v[178:179], v209 offset:49664
  buffer_load_dwordx4 v6, s[24:27], s62 offen offset:3072 lds
  s_waitcnt lgkmcnt(4)
  v_mfma_f32_32x32x16_bf16 v[140:155], v[196:199], a[44:47], v[140:155]
  ds_read_b64_tr_b16 v[180:181], v210 offset:49152
  ds_read_b64_tr_b16 v[182:183], v210 offset:49664
  v_mfma_f32_32x32x16_bf16 v[156:171], v[200:203], a[44:47], v[156:171]
  ds_read_b64_tr_b16 v[184:185], v211 offset:49152
  ds_read_b64_tr_b16 v[186:187], v211 offset:49664
  s_add_u32 m0, s64, 81920
  s_add_u32 s62, s65, 393216
  buffer_load_dwordx4 v3, s[24:27], s62 offen offset:0 lds
  s_waitcnt lgkmcnt(4)
  v_mfma_f32_32x32x16_bf16 v[108:123], v[172:175], a[48:51], v[108:123]
  ds_read_b64_tr_b16 v[188:189], v208 offset:50176
  ds_read_b64_tr_b16 v[190:191], v208 offset:50688
  v_mfma_f32_32x32x16_bf16 v[124:139], v[176:179], a[48:51], v[124:139]
  ds_read_b64_tr_b16 v[192:193], v209 offset:50176
  ds_read_b64_tr_b16 v[194:195], v209 offset:50688
  buffer_load_dwordx4 v4, s[24:27], s62 offen offset:1024 lds
  s_waitcnt lgkmcnt(4)
  v_mfma_f32_32x32x16_bf16 v[140:155], v[180:183], a[48:51], v[140:155]
  ds_read_b64_tr_b16 v[196:197], v210 offset:50176
  ds_read_b64_tr_b16 v[198:199], v210 offset:50688
  v_mfma_f32_32x32x16_bf16 v[156:171], v[184:187], a[48:51], v[156:171]
  ds_read_b64_tr_b16 v[200:201], v211 offset:50176
  ds_read_b64_tr_b16 v[202:203], v211 offset:50688
  buffer_load_dwordx4 v5, s[24:27], s62 offen offset:2048 lds
  s_waitcnt lgkmcnt(4)
  v_mfma_f32_32x32x16_bf16 v[108:123], v[188:191], a[52:55], v[108:123]
  ds_read_b64_tr_b16 v[172:173], v208 offset:53248
  ds_read_b64_tr_b16 v[174:175], v208 offset:53760
  v_mfma_f32_32x32x16_bf16 v[124:139], v[192:195], a[52:55], v[124:139]
  ds_read_b64_tr_b16 v[176:177], v209 offset:53248
  ds_read_b64_tr_b16 v[178:179], v209 offset:53760
  buffer_load_dwordx4 v6, s[24:27], s62 offen offset:3072 lds
  s_waitcnt lgkmcnt(4)
  v_mfma_f32_32x32x16_bf16 v[140:155], v[196:199], a[52:55], v[140:155]
  ds_read_b64_tr_b16 v[180:181], v210 offset:53248
  ds_read_b64_tr_b16 v[182:183], v210 offset:53760
  v_mfma_f32_32x32x16_bf16 v[156:171], v[200:203], a[52:55], v[156:171]
  ds_read_b64_tr_b16 v[184:185], v211 offset:53248
  ds_read_b64_tr_b16 v[186:187], v211 offset:53760
  s_waitcnt lgkmcnt(4)
  v_mfma_f32_32x32x16_bf16 v[108:123], v[172:175], a[56:59], v[108:123]
  ds_read_b64_tr_b16 v[188:189], v208 offset:54272
  ds_read_b64_tr_b16 v[190:191], v208 offset:54784
  ds_read_b64_tr_b16 v[192:193], v209 offset:54272
  ds_read_b64_tr_b16 v[194:195], v209 offset:54784
  v_mfma_f32_32x32x16_bf16 v[124:139], v[176:179], a[56:59], v[124:139]
  ds_read_b64_tr_b16 v[196:197], v210 offset:54272
  ds_read_b64_tr_b16 v[198:199], v210 offset:54784
  ds_read_b64_tr_b16 v[200:201], v211 offset:54272
  ds_read_b64_tr_b16 v[202:203], v211 offset:54784
  s_waitcnt lgkmcnt(8)
  v_mfma_f32_32x32x16_bf16 v[140:155], v[180:183], a[56:59], v[140:155]
  v_mfma_f32_32x32x16_bf16 v[156:171], v[184:187], a[56:59], v[156:171]
  s_waitcnt vmcnt(28)
  s_waitcnt lgkmcnt(0)
  v_mfma_f32_32x32x16_bf16 v[108:123], v[188:191], a[60:63], v[108:123]
  s_barrier
  v_mfma_f32_32x32x16_bf16 v[124:139], v[192:195], a[60:63], v[124:139]
  ds_read_b64_tr_b16 v[172:173], v212 offset:0
  ds_read_b64_tr_b16 v[174:175], v212 offset:512
  ds_read_b64_tr_b16 v[176:177], v213 offset:0
  s_add_u32 m0, s64, 98304
  s_add_u32 s62, s65, 524288
  buffer_load_dwordx4 v3, s[24:27], s62 offen offset:0 lds
  v_mfma_f32_32x32x16_bf16 v[140:155], v[196:199], a[60:63], v[140:155]
  ds_read_b64_tr_b16 v[178:179], v213 offset:512
  ds_read_b64_tr_b16 v[180:181], v214 offset:0
  ds_read_b64_tr_b16 v[182:183], v214 offset:512
  s_waitcnt vmcnt(10)
  s_mov_b64 exec, 1
  s_add_u32 s53, s56, 81920
  s_cmp_eq_u32 s96, 0
  s_cbranch_scc1 Lfar31
  buffer_store_dword v251, off, s[32:35], s53
Lback32:
  s_mov_b64 exec, -1
  v_mfma_f32_32x32x16_bf16 v[156:171], v[200:203], a[60:63], v[156:171]
  ds_read_b64_tr_b16 v[184:185], v215 offset:0
  ds_read_b64_tr_b16 v[186:187], v215 offset:512
  buffer_load_dwordx4 v4, s[24:27], s62 offen offset:1024 lds
  s_waitcnt lgkmcnt(4)
  v_mfma_f32_32x32x16_bf16 v[108:123], v[172:175], a[64:67], v[108:123]
  ds_read_b64_tr_b16 v[188:189], v212 offset:1024
  ds_read_b64_tr_b16 v[190:191], v212 offset:1536
  v_mfma_f32_32x32x16_bf16 v[124:139], v[176:179], a[64:67], v[124:139]
  ds_read_b64_tr_b16 v[192:193], v213 offset:1024
  ds_read_b64_tr_b16 v[194:195], v213 offset:1536
  buffer_load_dwordx4 v5, s[24:27], s62 offen offset:2048 lds
  s_waitcnt lgkmcnt(4)
  v_mfma_f32_32x32x16_bf16 v[140:155], v[180:183], a[64:67], v[140:155]
  ds_read_b64_tr_b16 v[196:197], v214 offset:1024
  ds_read_b64_tr_b16 v[198:199], v214 offset:1536
  v_mfma_f32_32x32x16_bf16 v[156:171], v[184:187], a[64:67], v[156:171]
  ds_read_b64_tr_b16 v[200:201], v215 offset:1024
  ds_read_b64_tr_b16 v[202:203], v215 offset:1536
  buffer_load_dwordx4 v6, s[24:27], s62 offen offset:3072 lds
  s_waitcnt lgkmcnt(4)
  v_mfma_f32_32x32x16_bf16 v[108:123], v[188:191], a[68:71], v[108:123]
  ds_read_b64_tr_b16 v[172:173], v212 offset:4096
  ds_read_b64_tr_b16 v[174:175], v212 offset:4608
  v_mfma_f32_32x32x16_bf16 v[124:139], v[192:195], a[68:71], v[124:139]
  ds_read_b64_tr_b16 v[176:177], v213 offset:4096
  ds_read_b64_tr_b16 v[178:179], v213 offset:4608
  s_add_u32 m0, s64, 114688
  s_add_u32 s62, s65, 655360
  buffer_load_dwordx4 v3, s[24:27], s62 offen offset:0 lds
  s_waitcnt lgkmcnt(4)
  v_mfma_f32_32x32x16_bf16 v[140:155], v[196:199], a[68:71], v[140:155]
  ds_read_b64_tr_b16 v[180:181], v214 offset:4096
  ds_read_b64_tr_b16 v[182:183], v214 offset:4608
  v_mfma_f32_32x32x16_bf16 v[156:171], v[200:203], a[68:71], v[156:171]
  ds_read_b64_tr_b16 v[184:185], v215 offset:4096
  ds_read_b64_tr_b16 v[186:187], v215 offset:4608
  buffer_load_dwordx4 v4, s[24:27], s62 offen offset:1024 lds
  s_waitcnt lgkmcnt(4)
  v_mfma_f32_32x32x16_bf16 v[108:123], v[172:175], a[72:75], v[108:123]
  ds_read_b64_tr_b16 v[188:189], v212 offset:5120
  ds_read_b64_tr_b16 v[190:191], v212 offset:5632
  v_mfma_f32_32x32x16_bf16 v[124:139], v[176:179], a[72:75], v[124:139]
  ds_read_b64_tr_b16 v[192:193], v213 offset:5120
  ds_read_b64_tr_b16 v[194:195], v213 offset:5632
  buffer_load_dwordx4 v5, s[24:27], s62 offen offset:2048 lds
  s_waitcnt lgkmcnt(4)
  v_mfma_f32_32x32x16_bf16 v[140:155], v[180:183], a[72:75], v[140:155]
  ds_read_b64_tr_b16 v[196:197], v214 offset:5120
  ds_read_b64_tr_b16 v[198:199], v214 offset:5632
  v_mfma_f32_32x32x16_bf16 v[156:171], v[184:187], a[72:75], v[156:171]
  ds_read_b64_tr_b16 v[200:201], v215 offset:5120
  ds_read_b64_tr_b16 v[202:203], v215 offset:5632
  buffer_load_dwordx4 v6, s[24:27], s62 offen offset:3072 lds
  s_waitcnt lgkmcnt(4)
  v_mfma_f32_32x32x16_bf16 v[108:123], v[188:191], a[76:79], v[108:123]
  ds_read_b64_tr_b16 v[172:173], v204 offset:0
  ds_read_b64_tr_b16 v[174:175], v204 offset:512
  v_bfe_u32 v20, v1, 2, 2
  v_and_b32 v21, 1, v1
  v_lshlrev_b32 v21, 1, v21
  v_mfma_f32_32x32x16_bf16 v[124:139], v[192:195], a[76:79], v[124:139]
  ds_read_b64_tr_b16 v[176:177], v205 offset:0
  ds_read_b64_tr_b16 v[178:179], v205 offset:512
  v_bfe_u32 v22, v1, 4, 1
  v_add_u32_e64 v21, v21, v22
  v_lshrrev_b32 v22, 1, v20
  s_waitcnt lgkmcnt(4)
  v_mfma_f32_32x32x16_bf16 v[140:155], v[196:199], a[76:79], v[140:155]
  ds_read_b64_tr_b16 v[180:181], v206 offset:0
  ds_read_b64_tr_b16 v[182:183], v206 offset:512
  v_xor_b32_e64 v22, s47, v22
  v_lshl_add_u32 v21, v22, 2, v21
  v_lshlrev_b32_e64 v21, 4, v21
  v_mfma_f32_32x32x16_bf16 v[156:171], v[200:203], a[76:79], v[156:171]
  ds_read_b64_tr_b16 v[184:185], v207 offset:0
  ds_read_b64_tr_b16 v[186:187], v207 offset:512
  v_bfe_u32 v22, v1, 1, 1
  v_lshl_add_u32 v21, v22, 3, v21
  v_lshrrev_b32 v22, 5, v1
  s_waitcnt lgkmcnt(4)
  v_mfma_f32_32x32x16_bf16 v[108:123], v[172:175], a[80:83], v[108:123]
  ds_read_b64_tr_b16 v[188:189], v204 offset:1024
  ds_read_b64_tr_b16 v[190:191], v204 offset:1536
  v_lshl_add_u32 v20, v22, 2, v20
  v_lshl_add_u32 v36, v20, 7, v21
  s_lshl_b32 s50, s47, 13
  v_mfma_f32_32x32x16_bf16 v[124:139], v[176:179], a[80:83], v[124:139]
  ds_read_b64_tr_b16 v[192:193], v205 offset:1024
  ds_read_b64_tr_b16 v[194:195], v205 offset:1536
  v_add_u32 v36, s50, v36
  v_xor_b32 v37, 64, v36
  v_add_u32 v38, 65536, v36
  s_waitcnt lgkmcnt(4)
  v_mfma_f32_32x32x16_bf16 v[140:155], v[180:183], a[80:83], v[140:155]
  ds_read_b64_tr_b16 v[196:197], v206 offset:1024
  ds_read_b64_tr_b16 v[198:199], v206 offset:1536
  v_add_u32 v39, 65536, v37
  v_add_u32 v40, 131072, v36
  v_add_u32 v41, 131072, v37
  v_mfma_f32_32x32x16_bf16 v[156:171], v[184:187], a[80:83], v[156:171]
  ds_read_b64_tr_b16 v[200:201], v207 offset:1024
  ds_read_b64_tr_b16 v[202:203], v207 offset:1536
  v_lshlrev_b32_e64 v44, 16, v12
  v_and_b32 v45, 0xffff0000, v12
  v_lshlrev_b32 v46, 16, v13
  s_waitcnt lgkmcnt(4)
  v_mfma_f32_32x32x16_bf16 v[108:123], v[188:191], a[84:87], v[108:123]
  ds_read_b64_tr_b16 v[172:173], v204 offset:4096
  ds_read_b64_tr_b16 v[174:175], v204 offset:4608
  v_and_b32 v47, 0xffff0000, v13
  v_lshlrev_b32_e64 v48, 16, v14
  v_and_b32 v49, 0xffff0000, v14
  v_mfma_f32_32x32x16_bf16 v[124:139], v[192:195], a[84:87], v[124:139]
  ds_read_b64_tr_b16 v[176:177], v205 offset:4096
  ds_read_b64_tr_b16 v[178:179], v205 offset:4608
  s_add_u32 s38, s57, 81920
  buffer_load_dword v255, v254, s[32:35], s38 offen sc1
  v_lshlrev_b32 v50, 16, v15
  s_waitcnt lgkmcnt(4)
  v_mfma_f32_32x32x16_bf16 v[140:155], v[196:199], a[84:87], v[140:155]
  ds_read_b64_tr_b16 v[180:181], v206 offset:4096
  ds_read_b64_tr_b16 v[182:183], v206 offset:4608
  v_and_b32 v51, 0xffff0000, v15
  v_lshlrev_b32_e64 v52, 16, v16
  v_and_b32 v53, 0xffff0000, v16
  v_mfma_f32_32x32x16_bf16 v[156:171], v[200:203], a[84:87], v[156:171]
  ds_read_b64_tr_b16 v[184:185], v207 offset:4096
  ds_read_b64_tr_b16 v[186:187], v207 offset:4608
  v_lshlrev_b32_e64 v54, 16, v17
  v_and_b32 v55, 0xffff0000, v17
  v_lshlrev_b32 v56, 16, v18
  s_waitcnt lgkmcnt(4)
  v_mfma_f32_32x32x16_bf16 v[108:123], v[172:175], a[88:91], v[108:123]
  ds_read_b64_tr_b16 v[188:189], v204 offset:5120
  ds_read_b64_tr_b16 v[190:191], v204 offset:5632
  ds_read_b64_tr_b16 v[192:193], v205 offset:5120
  ds_read_b64_tr_b16 v[194:195], v205 offset:5632
  v_and_b32 v57, 0xffff0000, v18
  v_mfma_f32_32x32x16_bf16 v[124:139], v[176:179], a[88:91], v[124:139]
  ds_read_b64_tr_b16 v[196:197], v206 offset:5120
  ds_read_b64_tr_b16 v[198:199], v206 offset:5632
  ds_read_b64_tr_b16 v[200:201], v207 offset:5120
  ds_read_b64_tr_b16 v[202:203], v207 offset:5632
  v_lshlrev_b32 v58, 16, v19
  s_waitcnt lgkmcnt(8)
  v_mfma_f32_32x32x16_bf16 v[140:155], v[180:183], a[88:91], v[140:155]
  v_and_b32 v59, 0xffff0000, v19
  s_xor_b32 s50, s40, 1
  s_lshl_b32 s50, s50, 12
  s_add_u32 s50, s50, 98304
  v_add_u32 v33, s50, v2
  v_mfma_f32_32x32x16_bf16 v[156:171], v[184:187], a[88:91], v[156:171]
  v_xor_b32 v34, 4096, v33
  s_lshl_b32 s50, s46, 12
  s_add_u32 s50, s50, 114688
  v_lshrrev_b32 v20, 5, v1
  s_lshl_b32 s51, s47, 1
  s_waitcnt lgkmcnt(0)
  v_mfma_f32_32x32x16_bf16 v[108:123], v[188:191], a[92:95], v[108:123]
  s_barrier
  v_mfma_f32_32x32x16_bf16 v[124:139], v[192:195], a[92:95], v[124:139]
  ds_read_b64_tr_b16 v[172:173], v204 offset:16384
  ds_read_b64_tr_b16 v[174:175], v204 offset:16896
  ds_read_b64_tr_b16 v[176:177], v205 offset:16384
  s_add_u32 m0, s64, 131072
  s_add_u32 s62, s65, 786432
  buffer_load_dwordx4 v3, s[24:27], s62 offen offset:0 lds
  v_mfma_f32_32x32x16_bf16 v[140:155], v[196:199], a[92:95], v[140:155]
  ds_read_b64_tr_b16 v[178:179], v205 offset:16896
  ds_read_b64_tr_b16 v[180:181], v206 offset:16384
  ds_read_b64_tr_b16 v[182:183], v206 offset:16896
  v_add_lshl_u32 v20, v20, s51, 1
  v_and_b32_e64 v21, 7, v1
  v_mfma_f32_32x32x16_bf16 v[156:171], v[200:203], a[92:95], v[156:171]
  ds_read_b64_tr_b16 v[184:185], v207 offset:16384
  ds_read_b64_tr_b16 v[186:187], v207 offset:16896
  buffer_load_dwordx4 v4, s[24:27], s62 offen offset:1024 lds
  v_xor_b32_e64 v20, v20, v21
  v_and_b32 v22, 31, v1
  s_waitcnt lgkmcnt(4)
  v_mfma_f32_32x32x16_bf16 v[108:123], v[172:175], a[96:99], v[108:123]
  ds_read_b64_tr_b16 v[188:189], v204 offset:17408
  ds_read_b64_tr_b16 v[190:191], v204 offset:17920
  v_lshlrev_b32_e64 v22, 7, v22
  v_lshl_add_u32 v20, v20, 4, v22
  v_add_u32_e64 v42, s50, v20
  v_mfma_f32_32x32x16_bf16 v[124:139], v[176:179], a[96:99], v[124:139]
  ds_read_b64_tr_b16 v[192:193], v205 offset:17408
  ds_read_b64_tr_b16 v[194:195], v205 offset:17920
  buffer_load_dwordx4 v5, s[24:27], s62 offen offset:2048 lds
  v_xor_b32_e64 v43, 16, v42
  v_lshrrev_b32 v22, 3, v1
  s_waitcnt lgkmcnt(4)
  v_mfma_f32_32x32x16_bf16 v[140:155], v[180:183], a[96:99], v[140:155]
  ds_read_b64_tr_b16 v[196:197], v206 offset:17408
  ds_read_b64_tr_b16 v[198:199], v206 offset:17920
  v_xor_b32 v20, v21, v22
  v_lshlrev_b32 v20, 4, v20
  v_lshl_add_u32 v20, v22, 7, v20
  v_mfma_f32_32x32x16_bf16 v[156:171], v[184:187], a[96:99], v[156:171]
  ds_read_b64_tr_b16 v[200:201], v207 offset:17408
  ds_read_b64_tr_b16 v[202:203], v207 offset:17920
  buffer_load_dwordx4 v6, s[24:27], s62 offen offset:3072 lds
  s_lshl_b32 s51, s47, 11
  s_add_u32 s50, s50, s51
  s_mov_b32 s59, 0
  s_waitcnt vmcnt(4)
  v_cmp_ne_u32 vcc, s45, v255
  s_nop 0
  s_cbranch_vccnz Lpoll33
Lpdone34:
  s_waitcnt lgkmcnt(4)
  v_mfma_f32_32x32x16_bf16 v[108:123], v[188:191], a[100:103], v[108:123]
  ds_read_b64_tr_b16 v[172:173], v204 offset:20480
  ds_read_b64_tr_b16 v[174:175], v204 offset:20992
  v_add_u32_e64 v35, s50, v20
  s_lshl_b32 s50, s68, 5
  s_add_u32 s50, s50, s47
  v_mfma_f32_32x32x16_bf16 v[124:139], v[192:195], a[100:103], v[124:139]
  ds_read_b64_tr_b16 v[176:177], v205 offset:20480
  ds_read_b64_tr_b16 v[178:179], v205 offset:20992
  s_add_u32 m0, s64, 0
  s_add_u32 s62, s65, 65536
  buffer_load_dwordx4 v3, s[24:27], s62 offen offset:0 lds
  s_waitcnt lgkmcnt(4)
  v_mfma_f32_32x32x16_bf16 v[140:155], v[196:199], a[100:103], v[140:155]
  ds_read_b64_tr_b16 v[180:181], v206 offset:20480
  ds_read_b64_tr_b16 v[182:183], v206 offset:20992
  s_lshl3_add_u32 s50, s50, s44
  s_lshl_b32 s50, s50, 7
  v_lshlrev_b32_e64 v21, 4, v21
  v_mfma_f32_32x32x16_bf16 v[156:171], v[200:203], a[100:103], v[156:171]
  ds_read_b64_tr_b16 v[184:185], v207 offset:20480
  ds_read_b64_tr_b16 v[186:187], v207 offset:20992
  s_add_u32 s63, s21, 5242880
  buffer_load_dwordx4 a[128:131], v2, s[32:35], s63 offen offset:0 sc1
  v_lshl_add_u32 v21, v22, 11, v21
  s_waitcnt lgkmcnt(4)
  v_mfma_f32_32x32x16_bf16 v[108:123], v[172:175], a[104:107], v[108:123]
  ds_read_b64_tr_b16 v[188:189], v204 offset:21504
  ds_read_b64_tr_b16 v[190:191], v204 offset:22016
  v_add_u32_e64 v252, s50, v21
  s_movk_i32 s36, 16384
  v_mfma_f32_32x32x16_bf16 v[124:139], v[176:179], a[104:107], v[124:139]
  ds_read_b64_tr_b16 v[192:193], v205 offset:21504
  ds_read_b64_tr_b16 v[194:195], v205 offset:22016
  buffer_load_dwordx4 v4, s[24:27], s62 offen offset:1024 lds
  s_waitcnt lgkmcnt(4)
  v_mfma_f32_32x32x16_bf16 v[140:155], v[180:183], a[104:107], v[140:155]
  ds_read_b64_tr_b16 v[196:197], v206 offset:21504
  ds_read_b64_tr_b16 v[198:199], v206 offset:22016
  v_mfma_f32_32x32x16_bf16 v[156:171], v[184:187], a[104:107], v[156:171]
  ds_read_b64_tr_b16 v[200:201], v207 offset:21504
  ds_read_b64_tr_b16 v[202:203], v207 offset:22016
  buffer_load_dwordx4 a[132:135], v2, s[32:35], s63 offen offset:1024 sc1
  s_waitcnt lgkmcnt(4)
  v_mfma_f32_32x32x16_bf16 v[108:123], v[188:191], a[108:111], v[108:123]
  ds_read_b64_tr_b16 v[172:173], v204 offset:32768
  ds_read_b64_tr_b16 v[174:175], v204 offset:33280
  v_mfma_f32_32x32x16_bf16 v[124:139], v[192:195], a[108:111], v[124:139]
  ds_read_b64_tr_b16 v[176:177], v205 offset:32768
  ds_read_b64_tr_b16 v[178:179], v205 offset:33280
  buffer_load_dwordx4 v5, s[24:27], s62 offen offset:2048 lds
  s_waitcnt lgkmcnt(4)
  v_mfma_f32_32x32x16_bf16 v[140:155], v[196:199], a[108:111], v[140:155]
  ds_read_b64_tr_b16 v[180:181], v206 offset:32768
  ds_read_b64_tr_b16 v[182:183], v206 offset:33280
  v_mfma_f32_32x32x16_bf16 v[156:171], v[200:203], a[108:111], v[156:171]
  ds_read_b64_tr_b16 v[184:185], v207 offset:32768
  ds_read_b64_tr_b16 v[186:187], v207 offset:33280
  buffer_load_dwordx4 a[136:139], v2, s[32:35], s63 offen offset:2048 sc1
  s_waitcnt lgkmcnt(4)
  v_mfma_f32_32x32x16_bf16 v[108:123], v[172:175], a[112:115], v[108:123]
  ds_read_b64_tr_b16 v[188:189], v204 offset:33792
  ds_read_b64_tr_b16 v[190:191], v204 offset:34304
  v_mfma_f32_32x32x16_bf16 v[124:139], v[176:179], a[112:115], v[124:139]
  ds_read_b64_tr_b16 v[192:193], v205 offset:33792
  ds_read_b64_tr_b16 v[194:195], v205 offset:34304
  buffer_load_dwordx4 v6, s[24:27], s62 offen offset:3072 lds
  s_waitcnt lgkmcnt(4)
  v_mfma_f32_32x32x16_bf16 v[140:155], v[180:183], a[112:115], v[140:155]
  ds_read_b64_tr_b16 v[196:197], v206 offset:33792
  ds_read_b64_tr_b16 v[198:199], v206 offset:34304
  v_mfma_f32_32x32x16_bf16 v[156:171], v[184:187], a[112:115], v[156:171]
  ds_read_b64_tr_b16 v[200:201], v207 offset:33792
  ds_read_b64_tr_b16 v[202:203], v207 offset:34304
  buffer_load_dwordx4 a[140:143], v2, s[32:35], s63 offen offset:3072 sc1
  s_waitcnt lgkmcnt(4)
  v_mfma_f32_32x32x16_bf16 v[108:123], v[188:191], a[116:119], v[108:123]
  ds_read_b64_tr_b16 v[172:173], v204 offset:36864
  ds_read_b64_tr_b16 v[174:175], v204 offset:37376
  v_mfma_f32_32x32x16_bf16 v[124:139], v[192:195], a[116:119], v[124:139]
  ds_read_b64_tr_b16 v[176:177], v205 offset:36864
  ds_read_b64_tr_b16 v[178:179], v205 offset:37376
  s_add_u32 s63, s21, 5251072
  buffer_load_dwordx4 a[144:147], v2, s[32:35], s63 offen offset:0 sc1
  s_waitcnt lgkmcnt(4)
  v_mfma_f32_32x32x16_bf16 v[140:155], v[196:199], a[116:119], v[140:155]
  ds_read_b64_tr_b16 v[180:181], v206 offset:36864
  ds_read_b64_tr_b16 v[182:183], v206 offset:37376
  v_mfma_f32_32x32x16_bf16 v[156:171], v[200:203], a[116:119], v[156:171]
  ds_read_b64_tr_b16 v[184:185], v207 offset:36864
  ds_read_b64_tr_b16 v[186:187], v207 offset:37376
  buffer_load_dwordx4 a[148:151], v2, s[32:35], s63 offen offset:1024 sc1
  s_waitcnt lgkmcnt(4)
  v_mfma_f32_32x32x16_bf16 v[108:123], v[172:175], a[120:123], v[108:123]
  ds_read_b64_tr_b16 v[188:189], v204 offset:37888
  ds_read_b64_tr_b16 v[190:191], v204 offset:38400
  ds_read_b64_tr_b16 v[192:193], v205 offset:37888
  ds_read_b64_tr_b16 v[194:195], v205 offset:38400
  v_mfma_f32_32x32x16_bf16 v[124:139], v[176:179], a[120:123], v[124:139]
  ds_read_b64_tr_b16 v[196:197], v206 offset:37888
  ds_read_b64_tr_b16 v[198:199], v206 offset:38400
  ds_read_b64_tr_b16 v[200:201], v207 offset:37888
  ds_read_b64_tr_b16 v[202:203], v207 offset:38400
  s_waitcnt lgkmcnt(8)
  v_mfma_f32_32x32x16_bf16 v[140:155], v[180:183], a[120:123], v[140:155]
  buffer_load_dwordx4 a[152:155], v2, s[32:35], s63 offen offset:2048 sc1
  v_mfma_f32_32x32x16_bf16 v[156:171], v[184:187], a[120:123], v[156:171]
  buffer_load_dwordx4 a[156:159], v2, s[32:35], s63 offen offset:3072 sc1
  s_waitcnt lgkmcnt(0)
  v_mfma_f32_32x32x16_bf16 v[108:123], v[188:191], a[124:127], v[108:123]
  s_barrier
  v_mfma_f32_32x32x16_bf16 v[124:139], v[192:195], a[124:127], v[124:139]
  v_mfma_f32_32x32x16_bf16 v[140:155], v[196:199], a[124:127], v[140:155]
  v_mfma_f32_32x32x16_bf16 v[156:171], v[200:203], a[124:127], v[156:171]
  v_mfma_f32_32x32x8_bf16 v[108:123], v[220:221], v[218:219], v[108:123]
  v_mfma_f32_32x32x8_bf16 v[124:139], v[222:223], v[218:219], v[124:139]
  v_mfma_f32_32x32x8_bf16 v[140:155], v[224:225], v[218:219], v[140:155]
  v_mfma_f32_32x32x8_bf16 v[156:171], v[226:227], v[218:219], v[156:171]
  s_add_u32 s55, s55, 4096
  s_nop 7
  v_pk_mul_f32 v[108:109], v[108:109], v[116:117]
  v_pk_mul_f32 v[110:111], v[110:111], v[118:119]
  v_pk_mul_f32 v[112:113], v[112:113], v[120:121]
  v_pk_mul_f32 v[114:115], v[114:115], v[122:123]
  v_pk_mul_f32 v[108:109], v[250:251], v[108:109] op_sel_hi:[0,1]
  v_pk_mul_f32 v[110:111], v[250:251], v[110:111] op_sel_hi:[0,1]
  v_pk_mul_f32 v[112:113], v[250:251], v[112:113] op_sel_hi:[0,1]
  v_pk_mul_f32 v[114:115], v[250:251], v[114:115] op_sel_hi:[0,1]
  v_cvt_pk_bf16_f32 v24, v108, v109
  v_cvt_pk_bf16_f32 v25, v110, v111
  v_cvt_pk_bf16_f32 v26, v112, v113
  v_cvt_pk_bf16_f32 v27, v114, v115
  buffer_store_dwordx4 v[24:27], v2, s[32:35], s55 offen offset:0 sc1
  v_pk_mul_f32 v[124:125], v[124:125], v[132:133]
  v_pk_mul_f32 v[126:127], v[126:127], v[134:135]
  v_pk_mul_f32 v[128:129], v[128:129], v[136:137]
  v_pk_mul_f32 v[130:131], v[130:131], v[138:139]
  v_pk_mul_f32 v[124:125], v[250:251], v[124:125] op_sel_hi:[0,1]
  v_pk_mul_f32 v[126:127], v[250:251], v[126:127] op_sel_hi:[0,1]
  v_pk_mul_f32 v[128:129], v[250:251], v[128:129] op_sel_hi:[0,1]
  v_pk_mul_f32 v[130:131], v[250:251], v[130:131] op_sel_hi:[0,1]
  v_cvt_pk_bf16_f32 v28, v124, v125
  v_cvt_pk_bf16_f32 v29, v126, v127
  v_cvt_pk_bf16_f32 v30, v128, v129
  v_cvt_pk_bf16_f32 v31, v130, v131
  buffer_store_dwordx4 v[28:31], v2, s[32:35], s55 offen offset:1024 sc1
  v_pk_mul_f32 v[140:141], v[140:141], v[148:149]
  v_pk_mul_f32 v[142:143], v[142:143], v[150:151]
  v_pk_mul_f32 v[144:145], v[144:145], v[152:153]
  v_pk_mul_f32 v[146:147], v[146:147], v[154:155]
  v_pk_mul_f32 v[140:141], v[250:251], v[140:141] op_sel_hi:[0,1]
  v_pk_mul_f32 v[142:143], v[250:251], v[142:143] op_sel_hi:[0,1]
  v_pk_mul_f32 v[144:145], v[250:251], v[144:145] op_sel_hi:[0,1]
  v_pk_mul_f32 v[146:147], v[250:251], v[146:147] op_sel_hi:[0,1]
  v_cvt_pk_bf16_f32 v24, v140, v141
  v_cvt_pk_bf16_f32 v25, v142, v143
  v_cvt_pk_bf16_f32 v26, v144, v145
  v_cvt_pk_bf16_f32 v27, v146, v147
  buffer_store_dwordx4 v[24:27], v2, s[32:35], s55 offen offset:2048 sc1
  v_pk_mul_f32 v[156:157], v[156:157], v[164:165]
  v_pk_mul_f32 v[158:159], v[158:159], v[166:167]
  v_pk_mul_f32 v[160:161], v[160:161], v[168:169]
  v_pk_mul_f32 v[162:163], v[162:163], v[170:171]
  v_pk_mul_f32 v[156:157], v[250:251], v[156:157] op_sel_hi:[0,1]
  v_pk_mul_f32 v[158:159], v[250:251], v[158:159] op_sel_hi:[0,1]
  v_pk_mul_f32 v[160:161], v[250:251], v[160:161] op_sel_hi:[0,1]
  v_pk_mul_f32 v[162:163], v[250:251], v[162:163] op_sel_hi:[0,1]
  v_cvt_pk_bf16_f32 v28, v156, v157
  v_cvt_pk_bf16_f32 v29, v158, v159
  v_cvt_pk_bf16_f32 v30, v160, v161
  v_cvt_pk_bf16_f32 v31, v162, v163
  buffer_store_dwordx4 v[28:31], v2, s[32:35], s55 offen offset:3072 sc1
Lp4:
  s_add_u32 s63, s21, 5259264
  buffer_load_dwordx4 a[160:163], v2, s[32:35], s63 offen offset:0 sc1
  buffer_load_dwordx4 a[164:167], v2, s[32:35], s63 offen offset:1024 sc1
  buffer_load_dwordx4 a[168:171], v2, s[32:35], s63 offen offset:2048 sc1
  buffer_load_dwordx4 a[172:175], v2, s[32:35], s63 offen offset:3072 sc1
  s_waitcnt vmcnt(13)
  s_barrier
  ds_read_b64_tr_b16 v[80:81], v37 offset:49152
  s_nop 0
  ds_read_b64_tr_b16 v[82:83], v37 offset:50176
  ds_read_b64_tr_b16 v[76:77], v36 offset:49152
  ds_read_b64_tr_b16 v[78:79], v36 offset:50176
  ds_read_b64_tr_b16 v[88:89], v37 offset:51200
  ds_read_b64_tr_b16 v[90:91], v37 offset:52224
  ds_read_b64_tr_b16 v[84:85], v36 offset:51200
  ds_read_b64_tr_b16 v[86:87], v36 offset:52224
  s_waitcnt lgkmcnt(4)
  v_mfma_f32_32x32x16_bf16 v[60:75], v[80:83], a[128:131], 0
  ds_read_b64_tr_b16 v[96:97], v37 offset:53248
  ds_read_b64_tr_b16 v[98:99], v37 offset:54272
  s_add_u32 s63, s21, 5267456
  buffer_load_dwordx4 a[176:179], v2, s[32:35], s63 offen offset:0 sc1
  v_mfma_f32_32x32x16_bf16 v[44:59], v[76:79], a[128:131], v[44:59]
  ds_read_b64_tr_b16 v[92:93], v36 offset:53248
  ds_read_b64_tr_b16 v[94:95], v36 offset:54272
  buffer_load_dwordx4 a[180:183], v2, s[32:35], s63 offen offset:1024 sc1
  s_waitcnt lgkmcnt(4)
  v_mfma_f32_32x32x16_bf16 v[60:75], v[88:91], a[132:135], v[60:75]
  ds_read_b64_tr_b16 v[104:105], v37 offset:55296
  ds_read_b64_tr_b16 v[106:107], v37 offset:56320
  buffer_load_dwordx4 a[184:187], v2, s[32:35], s63 offen offset:2048 sc1
  v_mfma_f32_32x32x16_bf16 v[44:59], v[84:87], a[132:135], v[44:59]
  ds_read_b64_tr_b16 v[100:101], v36 offset:55296
  ds_read_b64_tr_b16 v[102:103], v36 offset:56320
  s_waitcnt lgkmcnt(4)
  v_mfma_f32_32x32x16_bf16 v[60:75], v[96:99], a[136:139], v[60:75]
  ds_read_b64_tr_b16 v[80:81], v41 offset:16384
  ds_read_b64_tr_b16 v[82:83], v41 offset:17408
  buffer_load_dwordx4 a[188:191], v2, s[32:35], s63 offen offset:3072 sc1
  v_mfma_f32_32x32x16_bf16 v[44:59], v[92:95], a[136:139], v[44:59]
  ds_read_b64_tr_b16 v[76:77], v40 offset:16384
  ds_read_b64_tr_b16 v[78:79], v40 offset:17408
  s_add_u32 s63, s21, 5275648
  buffer_load_dwordx4 a[192:195], v2, s[32:35], s63 offen offset:0 sc1
  s_waitcnt vmcnt(17) lgkmcnt(4)
  v_mfma_f32_32x32x16_bf16 v[60:75], v[104:107], a[140:143], v[60:75]
  ds_read_b64_tr_b16 v[88:89], v41 offset:18432
  ds_read_b64_tr_b16 v[90:91], v41 offset:19456
  buffer_load_dwordx4 a[196:199], v2, s[32:35], s63 offen offset:1024 sc1
  v_mfma_f32_32x32x16_bf16 v[44:59], v[100:103], a[140:143], v[44:59]
  ds_read_b64_tr_b16 v[84:85], v40 offset:18432
  ds_read_b64_tr_b16 v[86:87], v40 offset:19456
  s_waitcnt vmcnt(17) lgkmcnt(4)
  v_mfma_f32_32x32x16_bf16 v[60:75], v[80:83], a[144:147], v[60:75]
  ds_read_b64_tr_b16 v[96:97], v41 offset:20480
  ds_read_b64_tr_b16 v[98:99], v41 offset:21504
  buffer_load_dwordx4 a[200:203], v2, s[32:35], s63 offen offset:2048 sc1
  v_mfma_f32_32x32x16_bf16 v[44:59], v[76:79], a[144:147], v[44:59]
  ds_read_b64_tr_b16 v[92:93], v40 offset:20480
  ds_read_b64_tr_b16 v[94:95], v40 offset:21504
  buffer_load_dwordx4 a[204:207], v2, s[32:35], s63 offen offset:3072 sc1
  s_waitcnt vmcnt(18) lgkmcnt(4)
  v_mfma_f32_32x32x16_bf16 v[60:75], v[88:91], a[148:151], v[60:75]
  ds_read_b64_tr_b16 v[104:105], v41 offset:22528
  ds_read_b64_tr_b16 v[106:107], v41 offset:23552
  s_add_u32 s63, s21, 5283840
  buffer_load_dwordx4 a[208:211], v2, s[32:35], s63 offen offset:0 sc1
  v_mfma_f32_32x32x16_bf16 v[44:59], v[84:87], a[148:151], v[44:59]
  ds_read_b64_tr_b16 v[100:101], v40 offset:22528
  ds_read_b64_tr_b16 v[102:103], v40 offset:23552
  s_waitcnt vmcnt(18) lgkmcnt(4)
  v_mfma_f32_32x32x16_bf16 v[60:75], v[96:99], a[152:155], v[60:75]
  ds_read_b64_tr_b16 v[80:81], v39 offset:0
  ds_read_b64_tr_b16 v[82:83], v39 offset:1024
  buffer_load_dwordx4 a[212:215], v2, s[32:35], s63 offen offset:1024 sc1
  v_mfma_f32_32x32x16_bf16 v[44:59], v[92:95], a[152:155], v[44:59]
  ds_read_b64_tr_b16 v[76:77], v38 offset:0
  ds_read_b64_tr_b16 v[78:79], v38 offset:1024
  buffer_load_dwordx4 a[216:219], v2, s[32:35], s63 offen offset:2048 sc1
  s_waitcnt vmcnt(15)
  s_cmp_ge_u32 s42, 14
  s_cbranch_scc1 Lnof3b
  s_mov_b64 exec, 1
  s_add_u32 s53, s56, 82432
  s_cmp_eq_u32 s96, 0
  s_cbranch_scc1 Lfar35
  buffer_store_dword v251, off, s[32:35], s53
Lback36:
  s_mov_b64 exec, -1
Lnof3b:
  s_waitcnt lgkmcnt(4)
  v_mfma_f32_32x32x16_bf16 v[60:75], v[104:107], a[156:159], v[60:75]
  ds_read_b64_tr_b16 v[88:89], v39 offset:2048
  ds_read_b64_tr_b16 v[90:91], v39 offset:3072
  buffer_load_dwordx4 a[220:223], v2, s[32:35], s63 offen offset:3072 sc1
  v_mfma_f32_32x32x16_bf16 v[44:59], v[100:103], a[156:159], v[44:59]
  ds_read_b64_tr_b16 v[84:85], v38 offset:2048
  ds_read_b64_tr_b16 v[86:87], v38 offset:3072
  s_waitcnt vmcnt(15) lgkmcnt(4)
  v_mfma_f32_32x32x16_bf16 v[60:75], v[80:83], a[160:163], v[60:75]
  ds_read_b64_tr_b16 v[96:97], v39 offset:4096
  ds_read_b64_tr_b16 v[98:99], v39 offset:5120
  s_add_u32 s63, s21, 5292032
  buffer_load_dwordx4 a[224:227], v2, s[32:35], s63 offen offset:0 sc1
  v_mfma_f32_32x32x16_bf16 v[44:59], v[76:79], a[160:163], v[44:59]
  ds_read_b64_tr_b16 v[92:93], v38 offset:4096
  ds_read_b64_tr_b16 v[94:95], v38 offset:5120
  buffer_load_dwordx4 a[228:231], v2, s[32:35], s63 offen offset:1024 sc1
  s_waitcnt vmcnt(16) lgkmcnt(4)
  v_mfma_f32_32x32x16_bf16 v[60:75], v[88:91], a[164:167], v[60:75]
  ds_read_b64_tr_b16 v[104:105], v39 offset:6144
  ds_read_b64_tr_b16 v[106:107], v39 offset:7168
  buffer_load_dwordx4 a[232:235], v2, s[32:35], s63 offen offset:2048 sc1
  v_mfma_f32_32x32x16_bf16 v[44:59], v[84:87], a[164:167], v[44:59]
  ds_read_b64_tr_b16 v[100:101], v38 offset:6144
  ds_read_b64_tr_b16 v[102:103], v38 offset:7168
  s_waitcnt vmcnt(16) lgkmcnt(4)
  v_mfma_f32_32x32x16_bf16 v[60:75], v[96:99], a[168:171], v[60:75]
  ds_read_b64_tr_b16 v[80:81], v39 offset:16384
  ds_read_b64_tr_b16 v[82:83], v39 offset:17408
  buffer_load_dwordx4 a[236:239], v2, s[32:35], s63 offen offset:3072 sc1
  v_mfma_f32_32x32x16_bf16 v[44:59], v[92:95], a[168:171], v[44:59]
  ds_read_b64_tr_b16 v[76:77], v38 offset:16384
  ds_read_b64_tr_b16 v[78:79], v38 offset:17408
  s_add_u32 m0, s64, 16384
  s_add_u32 s62, s65, 196608
  buffer_load_dwordx4 v3, s[24:27], s62 offen offset:0 lds
  s_waitcnt vmcnt(17) lgkmcnt(4)
  v_mfma_f32_32x32x16_bf16 v[60:75], v[104:107], a[172:175], v[60:75]
  ds_read_b64_tr_b16 v[88:89], v39 offset:18432
  ds_read_b64_tr_b16 v[90:91], v39 offset:19456
  buffer_load_dwordx4 v4, s[24:27], s62 offen offset:1024 lds
  v_mfma_f32_32x32x16_bf16 v[44:59], v[100:103], a[172:175], v[44:59]
  ds_read_b64_tr_b16 v[84:85], v38 offset:18432
  ds_read_b64_tr_b16 v[86:87], v38 offset:19456
  s_waitcnt vmcnt(17) lgkmcnt(4)
  v_mfma_f32_32x32x16_bf16 v[60:75], v[80:83], a[176:179], v[60:75]
  ds_read_b64_tr_b16 v[96:97], v39 offset:20480
  ds_read_b64_tr_b16 v[98:99], v39 offset:21504
  buffer_load_dwordx4 v5, s[24:27], s62 offen offset:2048 lds
  v_mfma_f32_32x32x16_bf16 v[44:59], v[76:79], a[176:179], v[44:59]
  ds_read_b64_tr_b16 v[92:93], v38 offset:20480
  ds_read_b64_tr_b16 v[94:95], v38 offset:21504
  buffer_load_dwordx4 v6, s[24:27], s62 offen offset:3072 lds
  s_waitcnt vmcnt(18) lgkmcnt(4)
  v_mfma_f32_32x32x16_bf16 v[60:75], v[88:91], a[180:183], v[60:75]
  ds_read_b64_tr_b16 v[104:105], v39 offset:22528
  ds_read_b64_tr_b16 v[106:107], v39 offset:23552
  s_add_u32 m0, s64, 32768
  s_add_u32 s62, s65, 327680
  buffer_load_dwordx4 v3, s[24:27], s62 offen offset:0 lds
  v_mfma_f32_32x32x16_bf16 v[44:59], v[84:87], a[180:183], v[44:59]
  ds_read_b64_tr_b16 v[100:101], v38 offset:22528
  ds_read_b64_tr_b16 v[102:103], v38 offset:23552
  buffer_load_dwordx4 v4, s[24:27], s62 offen offset:1024 lds
  s_waitcnt lgkmcnt(0)
  s_waitcnt vmcnt(19)
  v_mfma_f32_32x32x16_bf16 v[60:75], v[96:99], a[184:187], v[60:75]
  s_barrier
  ds_read_b64_tr_b16 v[80:81], v39 offset:32768
  ds_read_b64_tr_b16 v[82:83], v39 offset:33792
  v_mfma_f32_32x32x16_bf16 v[44:59], v[92:95], a[184:187], v[44:59]
  ds_read_b64_tr_b16 v[76:77], v38 offset:32768
  ds_read_b64_tr_b16 v[78:79], v38 offset:33792
  buffer_load_dwordx4 v5, s[24:27], s62 offen offset:2048 lds
  s_add_u32 s38, s57, 82432
  buffer_load_dword v255, v254, s[32:35], s38 offen sc1
  s_waitcnt vmcnt(20)
  v_mfma_f32_32x32x16_bf16 v[60:75], v[104:107], a[188:191], v[60:75]
  ds_read_b64_tr_b16 v[88:89], v39 offset:34816
  ds_read_b64_tr_b16 v[90:91], v39 offset:35840
  buffer_load_dwordx4 v6, s[24:27], s62 offen offset:3072 lds
  v_mfma_f32_32x32x16_bf16 v[44:59], v[100:103], a[188:191], v[44:59]
  ds_read_b64_tr_b16 v[84:85], v38 offset:34816
  ds_read_b64_tr_b16 v[86:87], v38 offset:35840
  s_add_u32 m0, s64, 49152
  s_add_u32 s62, s65, 458752
  buffer_load_dwordx4 v3, s[24:27], s62 offen offset:0 lds
  s_waitcnt vmcnt(21) lgkmcnt(4)
  v_mfma_f32_32x32x16_bf16 v[60:75], v[80:83], a[192:195], v[60:75]
  ds_read_b64_tr_b16 v[96:97], v39 offset:36864
  ds_read_b64_tr_b16 v[98:99], v39 offset:37888
  v_mfma_f32_32x32x16_bf16 v[44:59], v[76:79], a[192:195], v[44:59]
  ds_read_b64_tr_b16 v[92:93], v38 offset:36864
  ds_read_b64_tr_b16 v[94:95], v38 offset:37888
  buffer_load_dwordx4 v4, s[24:27], s62 offen offset:1024 lds
  s_waitcnt vmcnt(21) lgkmcnt(4)
  v_mfma_f32_32x32x16_bf16 v[60:75], v[88:91], a[196:199], v[60:75]
  ds_read_b64_tr_b16 v[104:105], v39 offset:38912
  ds_read_b64_tr_b16 v[106:107], v39 offset:39936
  buffer_load_dwordx4 v5, s[24:27], s62 offen offset:2048 lds
  v_mfma_f32_32x32x16_bf16 v[44:59], v[84:87], a[196:199], v[44:59]
  ds_read_b64_tr_b16 v[100:101], v38 offset:38912
  ds_read_b64_tr_b16 v[102:103], v38 offset:39936
  buffer_load_dwordx4 v6, s[24:27], s62 offen offset:3072 lds
  s_waitcnt vmcnt(22) lgkmcnt(4)
  v_mfma_f32_32x32x16_bf16 v[60:75], v[96:99], a[200:203], v[60:75]
  ds_read_b64_tr_b16 v[80:81], v39 offset:49152
  ds_read_b64_tr_b16 v[82:83], v39 offset:50176
  v_mfma_f32_32x32x16_bf16 v[44:59], v[92:95], a[200:203], v[44:59]
  ds_read_b64_tr_b16 v[76:77], v38 offset:49152
  ds_read_b64_tr_b16 v[78:79], v38 offset:50176
  s_add_u32 m0, s64, 147456
  s_add_u32 s62, s65, 589824
  buffer_load_dwordx4 v3, s[24:27], s62 offen offset:0 lds
  s_waitcnt vmcnt(22) lgkmcnt(4)
  v_mfma_f32_32x32x16_bf16 v[60:75], v[104:107], a[204:207], v[60:75]
  ds_read_b64_tr_b16 v[88:89], v39 offset:51200
  ds_read_b64_tr_b16 v[90:91], v39 offset:52224
  buffer_load_dwordx4 v4, s[24:27], s62 offen offset:1024 lds
  v_mfma_f32_32x32x16_bf16 v[44:59], v[100:103], a[204:207], v[44:59]
  ds_read_b64_tr_b16 v[84:85], v38 offset:51200
  ds_read_b64_tr_b16 v[86:87], v38 offset:52224
  buffer_load_dwordx4 v5, s[24:27], s62 offen offset:2048 lds
  s_mov_b32 s59, 0
  s_waitcnt vmcnt(8)
  v_cmp_ne_u32 vcc, s45, v255
  s_nop 0
  s_cbranch_vccnz Lpoll37
Lpdone38:
  s_waitcnt lgkmcnt(4)
  v_mfma_f32_32x32x16_bf16 v[60:75], v[80:83], a[208:211], v[60:75]
  ds_read_b64_tr_b16 v[96:97], v39 offset:53248
  ds_read_b64_tr_b16 v[98:99], v39 offset:54272
  v_mfma_f32_32x32x16_bf16 v[44:59], v[76:79], a[208:211], v[44:59]
  ds_read_b64_tr_b16 v[92:93], v38 offset:53248
  ds_read_b64_tr_b16 v[94:95], v38 offset:54272
  buffer_load_dwordx4 v6, s[24:27], s62 offen offset:3072 lds
  s_waitcnt lgkmcnt(4)
  v_mfma_f32_32x32x16_bf16 v[60:75], v[88:91], a[212:215], v[60:75]
  ds_read_b64_tr_b16 v[104:105], v39 offset:55296
  ds_read_b64_tr_b16 v[106:107], v39 offset:56320
  s_add_u32 s63, s21, 5246976
  buffer_load_dwordx4 a[0:3], v2, s[32:35], s63 offen offset:0 sc1
  v_mfma_f32_32x32x16_bf16 v[44:59], v[84:87], a[212:215], v[44:59]
  ds_read_b64_tr_b16 v[100:101], v38 offset:55296
  ds_read_b64_tr_b16 v[102:103], v38 offset:56320
  buffer_load_dwordx4 a[4:7], v2, s[32:35], s63 offen offset:1024 sc1
  s_waitcnt lgkmcnt(4)
  v_mfma_f32_32x32x16_bf16 v[60:75], v[96:99], a[216:219], v[60:75]
  ds_read_b64_tr_b16 v[80:81], v41 offset:0
  ds_read_b64_tr_b16 v[82:83], v41 offset:1024
  v_mfma_f32_32x32x16_bf16 v[44:59], v[92:95], a[216:219], v[44:59]
  ds_read_b64_tr_b16 v[76:77], v40 offset:0
  ds_read_b64_tr_b16 v[78:79], v40 offset:1024
  buffer_load_dwordx4 a[8:11], v2, s[32:35], s63 offen offset:2048 sc1
  s_waitcnt lgkmcnt(4)
  v_mfma_f32_32x32x16_bf16 v[60:75], v[104:107], a[220:223], v[60:75]
  ds_read_b64_tr_b16 v[88:89], v41 offset:2048
  ds_read_b64_tr_b16 v[90:91], v41 offset:3072
  buffer_load_dwordx4 a[12:15], v2, s[32:35], s63 offen offset:3072 sc1
  v_mfma_f32_32x32x16_bf16 v[44:59], v[100:103], a[220:223], v[44:59]
  ds_read_b64_tr_b16 v[84:85], v40 offset:2048
  ds_read_b64_tr_b16 v[86:87], v40 offset:3072
  s_add_u32 s63, s21, 5255168
  buffer_load_dwordx4 a[16:19], v2, s[32:35], s63 offen offset:0 sc1
  s_waitcnt lgkmcnt(4)
  v_mfma_f32_32x32x16_bf16 v[60:75], v[80:83], a[224:227], v[60:75]
  ds_read_b64_tr_b16 v[96:97], v41 offset:4096
  ds_read_b64_tr_b16 v[98:99], v41 offset:5120
  v_mfma_f32_32x32x16_bf16 v[44:59], v[76:79], a[224:227], v[44:59]
  ds_read_b64_tr_b16 v[92:93], v40 offset:4096
  ds_read_b64_tr_b16 v[94:95], v40 offset:5120
  buffer_load_dwordx4 a[20:23], v2, s[32:35], s63 offen offset:1024 sc1
  s_waitcnt lgkmcnt(4)
  v_mfma_f32_32x32x16_bf16 v[60:75], v[88:91], a[228:231], v[60:75]
  ds_read_b64_tr_b16 v[104:105], v41 offset:6144
  ds_read_b64_tr_b16 v[106:107], v41 offset:7168
  buffer_load_dwordx4 a[24:27], v2, s[32:35], s63 offen offset:2048 sc1
  v_mfma_f32_32x32x16_bf16 v[44:59], v[84:87], a[228:231], v[44:59]
  ds_read_b64_tr_b16 v[100:101], v40 offset:6144
  ds_read_b64_tr_b16 v[102:103], v40 offset:7168
  buffer_load_dwordx4 a[28:31], v2, s[32:35], s63 offen offset:3072 sc1
  s_waitcnt lgkmcnt(4)
  v_mfma_f32_32x32x16_bf16 v[60:75], v[96:99], a[232:235], v[60:75]
  ds_read_b64_tr_b16 v[80:81], v37 offset:0
  ds_read_b64_tr_b16 v[82:83], v37 offset:1024
  v_mfma_f32_32x32x16_bf16 v[44:59], v[92:95], a[232:235], v[44:59]
  ds_read_b64_tr_b16 v[76:77], v36 offset:0
  ds_read_b64_tr_b16 v[78:79], v36 offset:1024
  s_add_u32 s63, s21, 5263360
  buffer_load_dwordx4 a[32:35], v2, s[32:35], s63 offen offset:0 sc1
  s_waitcnt lgkmcnt(4)
  v_mfma_f32_32x32x16_bf16 v[60:75], v[104:107], a[236:239], v[60:75]
  ds_read_b64_tr_b16 v[88:89], v37 offset:2048
  ds_read_b64_tr_b16 v[90:91], v37 offset:3072
  buffer_load_dwordx4 a[36:39], v2, s[32:35], s63 offen offset:1024 sc1
  v_mfma_f32_32x32x16_bf16 v[44:59], v[100:103], a[236:239], v[44:59]
  ds_read_b64_tr_b16 v[84:85], v36 offset:2048
  ds_read_b64_tr_b16 v[86:87], v36 offset:3072
  buffer_load_dwordx4 a[40:43], v2, s[32:35], s63 offen offset:2048 sc1
  s_waitcnt vmcnt(10) lgkmcnt(4)
  v_mfma_f32_32x32x16_bf16 v[60:75], v[80:83], a[0:3], v[60:75]
  ds_read_b64_tr_b16 v[96:97], v37 offset:4096
  ds_read_b64_tr_b16 v[98:99], v37 offset:5120
  v_mfma_f32_32x32x16_bf16 v[44:59], v[76:79], a[0:3], v[44:59]
  ds_read_b64_tr_b16 v[92:93], v36 offset:4096
  ds_read_b64_tr_b16 v[94:95], v36 offset:5120
  buffer_load_dwordx4 a[44:47], v2, s[32:35], s63 offen offset:3072 sc1
  s_waitcnt vmcnt(10) lgkmcnt(4)
  v_mfma_f32_32x32x16_bf16 v[60:75], v[88:91], a[4:7], v[60:75]
  ds_read_b64_tr_b16 v[104:105], v37 offset:6144
  ds_read_b64_tr_b16 v[106:107], v37 offset:7168
  s_add_u32 s63, s21, 5271552
  buffer_load_dwordx4 a[48:51], v2, s[32:35], s63 offen offset:0 sc1
  v_mfma_f32_32x32x16_bf16 v[44:59], v[84:87], a[4:7], v[44:59]
  ds_read_b64_tr_b16 v[100:101], v36 offset:6144
  ds_read_b64_tr_b16 v[102:103], v36 offset:7168
  buffer_load_dwordx4 a[52:55], v2, s[32:35], s63 offen offset:1024 sc1
  s_waitcnt vmcnt(11) lgkmcnt(4)
  v_mfma_f32_32x32x16_bf16 v[60:75], v[96:99], a[8:11], v[60:75]
  s_barrier
  ds_read_b64_tr_b16 v[80:81], v37 offset:16384
  ds_read_b64_tr_b16 v[82:83], v37 offset:17408
  v_mfma_f32_32x32x16_bf16 v[44:59], v[92:95], a[8:11], v[44:59]
  ds_read_b64_tr_b16 v[76:77], v36 offset:16384
  ds_read_b64_tr_b16 v[78:79], v36 offset:17408
  buffer_load_dwordx4 a[56:59], v2, s[32:35], s63 offen offset:2048 sc1
  s_waitcnt vmcnt(11) lgkmcnt(4)
  v_mfma_f32_32x32x16_bf16 v[60:75], v[104:107], a[12:15], v[60:75]
  ds_read_b64_tr_b16 v[88:89], v37 offset:18432
  ds_read_b64_tr_b16 v[90:91], v37 offset:19456
  buffer_load_dwordx4 a[60:63], v2, s[32:35], s63 offen offset:3072 sc1
  v_mfma_f32_32x32x16_bf16 v[44:59], v[100:103], a[12:15], v[44:59]
  ds_read_b64_tr_b16 v[84:85], v36 offset:18432
  ds_read_b64_tr_b16 v[86:87], v36 offset:19456
  s_add_u32 s63, s21, 5279744
  buffer_load_dwordx4 a[64:67], v2, s[32:35], s63 offen offset:0 sc1
  s_waitcnt vmcnt(12) lgkmcnt(4)
  v_mfma_f32_32x32x16_bf16 v[60:75], v[80:83], a[16:19], v[60:75]
  ds_read_b64_tr_b16 v[96:97], v37 offset:20480
  ds_read_b64_tr_b16 v[98:99], v37 offset:21504
  buffer_load_dwordx4 a[68:71], v2, s[32:35], s63 offen offset:1024 sc1
  v_mfma_f32_32x32x16_bf16 v[44:59], v[76:79], a[16:19], v[44:59]
  ds_read_b64_tr_b16 v[92:93], v36 offset:20480
  ds_read_b64_tr_b16 v[94:95], v36 offset:21504
  s_waitcnt vmcnt(12) lgkmcnt(4)
  v_mfma_f32_32x32x16_bf16 v[60:75], v[88:91], a[20:23], v[60:75]
  ds_read_b64_tr_b16 v[104:105], v37 offset:22528
  ds_read_b64_tr_b16 v[106:107], v37 offset:23552
  buffer_load_dwordx4 a[72:75], v2, s[32:35], s63 offen offset:2048 sc1
  v_mfma_f32_32x32x16_bf16 v[44:59], v[84:87], a[20:23], v[44:59]
  ds_read_b64_tr_b16 v[100:101], v36 offset:22528
  ds_read_b64_tr_b16 v[102:103], v36 offset:23552
  buffer_load_dwordx4 a[76:79], v2, s[32:35], s63 offen offset:3072 sc1
  s_waitcnt vmcnt(13) lgkmcnt(4)
  v_mfma_f32_32x32x16_bf16 v[60:75], v[96:99], a[24:27], v[60:75]
  s_barrier
  ds_read_b64_tr_b16 v[80:81], v37 offset:32768
  ds_read_b64_tr_b16 v[82:83], v37 offset:33792
  s_add_u32 m0, s64, 65536
  s_add_u32 s62, s65, 720896
  buffer_load_dwordx4 v3, s[24:27], s62 offen offset:0 lds
  v_mfma_f32_32x32x16_bf16 v[44:59], v[92:95], a[24:27], v[44:59]
  ds_read_b64_tr_b16 v[76:77], v36 offset:32768
  ds_read_b64_tr_b16 v[78:79], v36 offset:33792
  s_waitcnt vmcnt(13) lgkmcnt(4)
  v_mfma_f32_32x32x16_bf16 v[60:75], v[104:107], a[28:31], v[60:75]
  ds_read_b64_tr_b16 v[88:89], v37 offset:34816
  ds_read_b64_tr_b16 v[90:91], v37 offset:35840
  buffer_load_dwordx4 v4, s[24:27], s62 offen offset:1024 lds
  v_mfma_f32_32x32x16_bf16 v[44:59], v[100:103], a[28:31], v[44:59]
  ds_read_b64_tr_b16 v[84:85], v36 offset:34816
  ds_read_b64_tr_b16 v[86:87], v36 offset:35840
  buffer_load_dwordx4 v5, s[24:27], s62 offen offset:2048 lds
  s_waitcnt vmcnt(14) lgkmcnt(4)
  v_mfma_f32_32x32x16_bf16 v[60:75], v[80:83], a[32:35], v[60:75]
  ds_read_b64_tr_b16 v[96:97], v37 offset:36864
  ds_read_b64_tr_b16 v[98:99], v37 offset:37888
  buffer_load_dwordx4 v6, s[24:27], s62 offen offset:3072 lds
  v_mfma_f32_32x32x16_bf16 v[44:59], v[76:79], a[32:35], v[44:59]
  ds_read_b64_tr_b16 v[92:93], v36 offset:36864
  ds_read_b64_tr_b16 v[94:95], v36 offset:37888
  s_waitcnt vmcnt(14) lgkmcnt(4)
  v_mfma_f32_32x32x16_bf16 v[60:75], v[88:91], a[36:39], v[60:75]
  ds_read_b64_tr_b16 v[104:105], v37 offset:38912
  ds_read_b64_tr_b16 v[106:107], v37 offset:39936
  s_add_u32 s63, s21, 5287936
  buffer_load_dwordx4 a[80:83], v2, s[32:35], s63 offen offset:0 sc1
  v_mfma_f32_32x32x16_bf16 v[44:59], v[84:87], a[36:39], v[44:59]
  ds_read_b64_tr_b16 v[100:101], v36 offset:38912
  ds_read_b64_tr_b16 v[102:103], v36 offset:39936
  buffer_load_dwordx4 a[84:87], v2, s[32:35], s63 offen offset:1024 sc1
  s_waitcnt vmcnt(15) lgkmcnt(4)
  v_mfma_f32_32x32x16_bf16 v[60:75], v[96:99], a[40:43], v[60:75]
  s_barrier
  ds_read_b64_tr_b16 v[80:81], v37 offset:49152
  ds_read_b64_tr_b16 v[82:83], v37 offset:50176
  buffer_load_dwordx4 a[88:91], v2, s[32:35], s63 offen offset:2048 sc1
  v_mfma_f32_32x32x16_bf16 v[44:59], v[92:95], a[40:43], v[44:59]
  ds_read_b64_tr_b16 v[76:77], v36 offset:49152
  ds_read_b64_tr_b16 v[78:79], v36 offset:50176
  s_waitcnt vmcnt(15) lgkmcnt(4)
  v_mfma_f32_32x32x16_bf16 v[60:75], v[104:107], a[44:47], v[60:75]
  ds_read_b64_tr_b16 v[88:89], v37 offset:51200
  ds_read_b64_tr_b16 v[90:91], v37 offset:52224
  buffer_load_dwordx4 a[92:95], v2, s[32:35], s63 offen offset:3072 sc1
  v_mfma_f32_32x32x16_bf16 v[44:59], v[100:103], a[44:47], v[44:59]
  ds_read_b64_tr_b16 v[84:85], v36 offset:51200
  ds_read_b64_tr_b16 v[86:87], v36 offset:52224
  s_add_u32 m0, s64, 81920
  s_add_u32 s62, s65, 851968
  buffer_load_dwordx4 v3, s[24:27], s62 offen offset:0 lds
  s_waitcnt vmcnt(16) lgkmcnt(4)
  v_mfma_f32_32x32x16_bf16 v[60:75], v[80:83], a[48:51], v[60:75]
  ds_read_b64_tr_b16 v[96:97], v37 offset:53248
  ds_read_b64_tr_b16 v[98:99], v37 offset:54272
  buffer_load_dwordx4 v4, s[24:27], s62 offen offset:1024 lds
  v_mfma_f32_32x32x16_bf16 v[44:59], v[76:79], a[48:51], v[44:59]
  ds_read_b64_tr_b16 v[92:93], v36 offset:53248
  ds_read_b64_tr_b16 v[94:95], v36 offset:54272
  s_waitcnt vmcnt(16) lgkmcnt(4)
  v_mfma_f32_32x32x16_bf16 v[60:75], v[88:91], a[52:55], v[60:75]
  ds_read_b64_tr_b16 v[104:105], v37 offset:55296
  ds_read_b64_tr_b16 v[106:107], v37 offset:56320
  buffer_load_dwordx4 v5, s[24:27], s62 offen offset:2048 lds
  v_mfma_f32_32x32x16_bf16 v[44:59], v[84:87], a[52:55], v[44:59]
  ds_read_b64_tr_b16 v[100:101], v36 offset:55296
  ds_read_b64_tr_b16 v[102:103], v36 offset:56320
  buffer_load_dwordx4 v6, s[24:27], s62 offen offset:3072 lds
  s_waitcnt vmcnt(17) lgkmcnt(4)
  v_mfma_f32_32x32x16_bf16 v[60:75], v[96:99], a[56:59], v[60:75]
  s_barrier
  ds_read_b64_tr_b16 v[80:81], v41 offset:16384
  ds_read_b64_tr_b16 v[82:83], v41 offset:17408
  s_add_u32 s63, s21, 5296128
  buffer_load_dwordx4 a[96:99], v2, s[32:35], s63 offen offset:0 sc1
  v_mfma_f32_32x32x16_bf16 v[44:59], v[92:95], a[56:59], v[44:59]
  ds_read_b64_tr_b16 v[76:77], v40 offset:16384
  ds_read_b64_tr_b16 v[78:79], v40 offset:17408
  buffer_load_dwordx4 a[100:103], v2, s[32:35], s63 offen offset:1024 sc1
  s_waitcnt vmcnt(18) lgkmcnt(4)
  v_mfma_f32_32x32x16_bf16 v[60:75], v[104:107], a[60:63], v[60:75]
  ds_read_b64_tr_b16 v[88:89], v41 offset:18432
  ds_read_b64_tr_b16 v[90:91], v41 offset:19456
  v_mfma_f32_32x32x16_bf16 v[44:59], v[100:103], a[60:63], v[44:59]
  ds_read_b64_tr_b16 v[84:85], v40 offset:18432
  ds_read_b64_tr_b16 v[86:87], v40 offset:19456
  buffer_load_dwordx4 a[104:107], v2, s[32:35], s63 offen offset:2048 sc1
  s_waitcnt vmcnt(18) lgkmcnt(4)
  v_mfma_f32_32x32x16_bf16 v[60:75], v[80:83], a[64:67], v[60:75]
  ds_read_b64_tr_b16 v[96:97], v41 offset:20480
  ds_read_b64_tr_b16 v[98:99], v41 offset:21504
  buffer_load_dwordx4 a[108:111], v2, s[32:35], s63 offen offset:3072 sc1
  v_mfma_f32_32x32x16_bf16 v[44:59], v[76:79], a[64:67], v[44:59]
  ds_read_b64_tr_b16 v[92:93], v40 offset:20480
  ds_read_b64_tr_b16 v[94:95], v40 offset:21504
  s_waitcnt vmcnt(18) lgkmcnt(4)
  v_mfma_f32_32x32x16_bf16 v[60:75], v[88:91], a[68:71], v[60:75]
  ds_read_b64_tr_b16 v[104:105], v41 offset:22528
  ds_read_b64_tr_b16 v[106:107], v41 offset:23552
  v_mfma_f32_32x32x16_bf16 v[44:59], v[84:87], a[68:71], v[44:59]
  ds_read_b64_tr_b16 v[100:101], v40 offset:22528
  ds_read_b64_tr_b16 v[102:103], v40 offset:23552
  s_waitcnt vmcnt(12)
  s_waitcnt lgkmcnt(4)
  v_mfma_f32_32x32x16_bf16 v[60:75], v[96:99], a[72:75], v[60:75]
  s_barrier
  ds_read_b64_tr_b16 v[80:81], v39 offset:0
  ds_read_b64_tr_b16 v[82:83], v39 offset:1024
  v_mfma_f32_32x32x16_bf16 v[44:59], v[92:95], a[72:75], v[44:59]
  ds_read_b64_tr_b16 v[76:77], v38 offset:0
  ds_read_b64_tr_b16 v[78:79], v38 offset:1024
  s_waitcnt lgkmcnt(4)
  v_mfma_f32_32x32x16_bf16 v[60:75], v[104:107], a[76:79], v[60:75]
  ds_read_b64_tr_b16 v[88:89], v39 offset:2048
  ds_read_b64_tr_b16 v[90:91], v39 offset:3072
  v_mfma_f32_32x32x16_bf16 v[44:59], v[100:103], a[76:79], v[44:59]
  ds_read_b64_tr_b16 v[84:85], v38 offset:2048
  ds_read_b64_tr_b16 v[86:87], v38 offset:3072
  s_waitcnt vmcnt(11) lgkmcnt(4)
  v_mfma_f32_32x32x16_bf16 v[60:75], v[80:83], a[80:83], v[60:75]
  ds_read_b64_tr_b16 v[96:97], v39 offset:4096
  ds_read_b64_tr_b16 v[98:99], v39 offset:5120
  v_mfma_f32_32x32x16_bf16 v[44:59], v[76:79], a[80:83], v[44:59]
  ds_read_b64_tr_b16 v[92:93], v38 offset:4096
  ds_read_b64_tr_b16 v[94:95], v38 offset:5120
  s_waitcnt vmcnt(10) lgkmcnt(4)
  v_mfma_f32_32x32x16_bf16 v[60:75], v[88:91], a[84:87], v[60:75]
  ds_read_b64_tr_b16 v[104:105], v39 offset:6144
  ds_read_b64_tr_b16 v[106:107], v39 offset:7168
  v_mfma_f32_32x32x16_bf16 v[44:59], v[84:87], a[84:87], v[44:59]
  ds_read_b64_tr_b16 v[100:101], v38 offset:6144
  ds_read_b64_tr_b16 v[102:103], v38 offset:7168
  s_waitcnt vmcnt(4)
  s_waitcnt lgkmcnt(4)
  v_mfma_f32_32x32x16_bf16 v[60:75], v[96:99], a[88:91], v[60:75]
  s_barrier
  ds_read_b64_tr_b16 v[80:81], v39 offset:16384
  ds_read_b64_tr_b16 v[82:83], v39 offset:17408
  v_mfma_f32_32x32x16_bf16 v[44:59], v[92:95], a[88:91], v[44:59]
  ds_read_b64_tr_b16 v[76:77], v38 offset:16384
  ds_read_b64_tr_b16 v[78:79], v38 offset:17408
  s_waitcnt lgkmcnt(4)
  v_mfma_f32_32x32x16_bf16 v[60:75], v[104:107], a[92:95], v[60:75]
  ds_read_b64_tr_b16 v[88:89], v39 offset:18432
  ds_read_b64_tr_b16 v[90:91], v39 offset:19456
  v_mfma_f32_32x32x16_bf16 v[44:59], v[100:103], a[92:95], v[44:59]
  ds_read_b64_tr_b16 v[84:85], v38 offset:18432
  ds_read_b64_tr_b16 v[86:87], v38 offset:19456
  s_waitcnt vmcnt(3) lgkmcnt(4)
  v_mfma_f32_32x32x16_bf16 v[60:75], v[80:83], a[96:99], v[60:75]
  ds_read_b64_tr_b16 v[96:97], v39 offset:20480
  ds_read_b64_tr_b16 v[98:99], v39 offset:21504
  v_mfma_f32_32x32x16_bf16 v[44:59], v[76:79], a[96:99], v[44:59]
  ds_read_b64_tr_b16 v[92:93], v38 offset:20480
  ds_read_b64_tr_b16 v[94:95], v38 offset:21504
  s_waitcnt vmcnt(2) lgkmcnt(4)
  v_mfma_f32_32x32x16_bf16 v[60:75], v[88:91], a[100:103], v[60:75]
  ds_read_b64_tr_b16 v[104:105], v39 offset:22528
  ds_read_b64_tr_b16 v[106:107], v39 offset:23552
  v_mfma_f32_32x32x16_bf16 v[44:59], v[84:87], a[100:103], v[44:59]
  ds_read_b64_tr_b16 v[100:101], v38 offset:22528
  ds_read_b64_tr_b16 v[102:103], v38 offset:23552
  s_waitcnt vmcnt(1) lgkmcnt(4)
  v_mfma_f32_32x32x16_bf16 v[60:75], v[96:99], a[104:107], v[60:75]
  s_waitcnt vmcnt(0) lgkmcnt(0)
  v_mfma_f32_32x32x16_bf16 v[60:75], v[104:107], a[108:111], v[60:75]
  v_mfma_f32_32x32x16_bf16 v[44:59], v[92:95], a[104:107], v[44:59]
  v_mfma_f32_32x32x16_bf16 v[44:59], v[100:103], a[108:111], v[44:59]
  s_nop 9
  ds_write_b128 v33, v[60:63] offset:0
  ds_write_b128 v33, v[64:67] offset:1024
  ds_write_b128 v33, v[68:71] offset:2048
  ds_write_b128 v33, v[72:75] offset:3072
  s_waitcnt lgkmcnt(0)
  s_barrier
  ds_read_b128 v[108:111], v34 offset:0
  ds_read_b128 v[112:115], v34 offset:1024
  ds_read_b128 v[116:119], v34 offset:2048
  ds_read_b128 v[120:123], v34 offset:3072
  s_waitcnt lgkmcnt(3)
  v_pk_add_f32 v[44:45], v[44:45], v[108:109]
  v_pk_add_f32 v[46:47], v[46:47], v[110:111]
  s_waitcnt lgkmcnt(2)
  v_pk_add_f32 v[48:49], v[48:49], v[112:113]
  v_pk_add_f32 v[50:51], v[50:51], v[114:115]
  s_waitcnt lgkmcnt(1)
  v_pk_add_f32 v[52:53], v[52:53], v[116:117]
  v_pk_add_f32 v[54:55], v[54:55], v[118:119]
  s_waitcnt lgkmcnt(0)
  v_pk_add_f32 v[56:57], v[56:57], v[120:121]
  v_pk_add_f32 v[58:59], v[58:59], v[122:123]
  v_cvt_pk_bf16_f32 v12, v44, v45
  v_cvt_pk_bf16_f32 v13, v46, v47
  v_cvt_pk_bf16_f32 v14, v48, v49
  v_cvt_pk_bf16_f32 v15, v50, v51
  v_cvt_pk_bf16_f32 v16, v52, v53
  v_cvt_pk_bf16_f32 v17, v54, v55
  v_cvt_pk_bf16_f32 v18, v56, v57
  v_cvt_pk_bf16_f32 v19, v58, v59
  ds_write_b128 v42, v[12:15]
  ds_write_b128 v43, v[16:19]
  s_waitcnt lgkmcnt(0)
  s_barrier
  ds_read_b128 v[84:87], v35 offset:0
  ds_read_b128 v[88:91], v35 offset:1024
  s_waitcnt lgkmcnt(1)
  buffer_store_dwordx4 v[84:87], v252, s[28:31], 0 offen sc1
  s_waitcnt lgkmcnt(0)
  buffer_store_dwordx4 v[88:91], v252, s[28:31], s36 offen sc1
Lexit:
  s_endpgm
Lsp7:
  s_mov_b32 s52, 4096
  buffer_load_dwordx4 v[168:171], v184, s[32:35], s52 offen sc1
  s_lshl_b32 s52, s41, 7
  s_add_u32 s52, s52, 36864
  buffer_load_dwordx2 v[172:173], v191, s[32:35], s52 offen sc1
  s_add_u32 s59, s59, 1
  s_cmp_ge_u32 s59, 1048576
  s_waitcnt vmcnt(0)
  v_xor_b32 v169, s45, v169
  v_xor_b32 v171, s45, v171
  v_xor_b32_e64 v172, s45, v172
  v_or3_b32 v169, v169, v171, v172
  v_cmp_ne_u32 vcc, 0, v169
  s_cbranch_scc1 Lspd8
  s_cbranch_vccnz Lsp7
  s_branch Lspd8
Lfar12:
  buffer_store_dwordx4 v[152:155], v2, s[32:35], s36 offen sc1
  buffer_store_dwordx4 v[156:159], v2, s[32:35], s37 offen sc1
  s_branch Lback13
Lfar14:
  buffer_store_dword v251, off, s[32:35], s53 sc1
  s_branch Lback15
Lpoll16:
  buffer_load_dword v255, v253, s[32:35], s38 offen sc1
  s_add_u32 s59, s59, 1
  s_cmp_ge_u32 s59, 1048576
  s_waitcnt vmcnt(0)
  v_cmp_ne_u32 vcc, s45, v255
  s_cbranch_scc1 Lpdone17
  s_cbranch_vccnz Lpoll16
  s_branch Lpdone17
Lfar18:
  buffer_store_dwordx4 v[12:15], v2, s[32:35], s48 offen sc1
  buffer_store_dwordx4 v[16:19], v2, s[32:35], s48 offen offset:1024 sc1
  s_branch Lback19
Lfar20:
  buffer_store_dword v92, v2, s[32:35], s49 offen sc1
  s_branch Lback21
Lfar22:
  buffer_store_dword v251, off, s[32:35], s53 sc1
  s_branch Lback23
Lpoll24:
  buffer_load_dword v255, v254, s[32:35], s38 offen sc1
  s_add_u32 s59, s59, 1
  s_cmp_ge_u32 s59, 1048576
  s_waitcnt vmcnt(0)
  v_cmp_ne_u32 vcc, s45, v255
  s_cbranch_scc1 Lpdone25
  s_cbranch_vccnz Lpoll24
  s_branch Lpdone25
Lpoll26:
  buffer_load_dword v255, v253, s[32:35], s38 offen sc1
  s_add_u32 s59, s59, 1
  s_cmp_ge_u32 s59, 1048576
  s_waitcnt vmcnt(0)
  v_cmp_ne_u32 vcc, s45, v255
  s_cbranch_scc1 Lpdone27
  s_cbranch_vccnz Lpoll26
  s_branch Lpdone27
Lsa29:
  s_lshl_b32 s50, s42, 11
  s_add_u32 s50, s50, 196608
  buffer_load_dwordx4 v[220:223], v32, s[32:35], s50 offen offset:0 sc1
  buffer_load_dwordx4 v[224:227], v32, s[32:35], s50 offen offset:16 sc1
  s_add_u32 s59, s59, 1
  s_cmp_ge_u32 s59, 1048576
  s_waitcnt vmcnt(0)
  v_xor_b32 v234, s45, v221
  v_xor_b32 v235, s45, v223
  v_xor_b32_e64 v236, s45, v225
  v_or3_b32 v234, v234, v235, v236
  v_xor_b32 v235, s45, v227
  v_or_b32 v234, v234, v235
  v_cmp_ne_u32 vcc, 0, v234
  s_cbranch_scc1 Lsad30
  s_cbranch_vccnz Lsa29
  s_branch Lsad30
Lfar31:
  buffer_store_dword v251, off, s[32:35], s53 sc1
  s_branch Lback32
Lpoll33:
  buffer_load_dword v255, v254, s[32:35], s38 offen sc1
  s_add_u32 s59, s59, 1
  s_cmp_ge_u32 s59, 1048576
  s_waitcnt vmcnt(0)
  v_cmp_ne_u32 vcc, s45, v255
  s_cbranch_scc1 Lpdone34
  s_cbranch_vccnz Lpoll33
  s_branch Lpdone34
Lfar35:
  buffer_store_dword v251, off, s[32:35], s53 sc1
  s_branch Lback36
Lpoll37:
  buffer_load_dword v255, v254, s[32:35], s38 offen sc1
  s_add_u32 s59, s59, 1
  s_cmp_ge_u32 s59, 1048576
  s_waitcnt vmcnt(0)
  v_cmp_ne_u32 vcc, s45, v255
  s_cbranch_scc1 Lpdone38
  s_cbranch_vccnz Lpoll37
  s_branch Lpdone38
Lspare:
  s_lshl_b32 s50, s40, 5
  v_xor_b32 v204, s50, v204
  v_xor_b32 v208, s50, v208
  v_xor_b32 v212, s50, v212
  v_mov_b32 v220, 0x3f803f80
  v_mov_b32 v221, 0x3f803f80
  v_mov_b32 v222, 0x3f803f80
  v_mov_b32 v223, 0x3f803f80
  s_waitcnt vmcnt(0)
  s_barrier
  ds_read_b64_tr_b16 v[76:77], v208 offset:0
  ds_read_b64_tr_b16 v[78:79], v208 offset:512
  ds_read_b64_tr_b16 v[80:81], v208 offset:1024
  ds_read_b64_tr_b16 v[82:83], v208 offset:1536
  ds_read_b64_tr_b16 v[84:85], v208 offset:4096
  ds_read_b64_tr_b16 v[86:87], v208 offset:4608
  ds_read_b64_tr_b16 v[88:89], v208 offset:5120
  ds_read_b64_tr_b16 v[90:91], v208 offset:5632
  ds_read_b64_tr_b16 v[92:93], v208 offset:16384
  ds_read_b64_tr_b16 v[94:95], v208 offset:16896
  s_waitcnt lgkmcnt(8)
  v_mfma_f32_32x32x16_bf16 v[44:59], v[220:223], v[76:79], 0
  ds_read_b64_tr_b16 v[96:97], v208 offset:17408
  ds_read_b64_tr_b16 v[98:99], v208 offset:17920
  s_waitcnt lgkmcnt(8)
  v_mfma_f32_32x32x16_bf16 v[44:59], v[220:223], v[80:83], v[44:59]
  ds_read_b64_tr_b16 v[100:101], v208 offset:20480
  ds_read_b64_tr_b16 v[102:103], v208 offset:20992
  s_waitcnt lgkmcnt(8)
  v_mfma_f32_32x32x16_bf16 v[44:59], v[220:223], v[84:87], v[44:59]
  ds_read_b64_tr_b16 v[104:105], v208 offset:21504
  ds_read_b64_tr_b16 v[106:107], v208 offset:22016
  s_waitcnt lgkmcnt(8)
  v_mfma_f32_32x32x16_bf16 v[44:59], v[220:223], v[88:91], v[44:59]
  ds_read_b64_tr_b16 v[108:109], v208 offset:32768
  ds_read_b64_tr_b16 v[110:111], v208 offset:33280
  s_waitcnt lgkmcnt(8)
  v_mfma_f32_32x32x16_bf16 v[44:59], v[220:223], v[92:95], v[44:59]
  ds_read_b64_tr_b16 v[112:113], v208 offset:33792
  ds_read_b64_tr_b16 v[114:115], v208 offset:34304
  s_waitcnt lgkmcnt(8)
  v_mfma_f32_32x32x16_bf16 v[44:59], v[220:223], v[96:99], v[44:59]
  ds_read_b64_tr_b16 v[116:117], v208 offset:36864
  ds_read_b64_tr_b16 v[118:119], v208 offset:37376
  s_waitcnt lgkmcnt(8)
  v_mfma_f32_32x32x16_bf16 v[44:59], v[220:223], v[100:103], v[44:59]
  ds_read_b64_tr_b16 v[120:121], v208 offset:37888
  ds_read_b64_tr_b16 v[122:123], v208 offset:38400
  s_waitcnt lgkmcnt(8)
  v_mfma_f32_32x32x16_bf16 v[44:59], v[220:223], v[104:107], v[44:59]
  ds_read_b64_tr_b16 v[124:125], v208 offset:49152
  ds_read_b64_tr_b16 v[126:127], v208 offset:49664
  s_waitcnt lgkmcnt(8)
  v_mfma_f32_32x32x16_bf16 v[44:59], v[220:223], v[108:111], v[44:59]
  ds_read_b64_tr_b16 v[128:129], v208 offset:50176
  ds_read_b64_tr_b16 v[130:131], v208 offset:50688
  s_waitcnt lgkmcnt(8)
  v_mfma_f32_32x32x16_bf16 v[44:59], v[220:223], v[112:115], v[44:59]
  ds_read_b64_tr_b16 v[132:133], v208 offset:53248
  ds_read_b64_tr_b16 v[134:135], v208 offset:53760
  s_waitcnt lgkmcnt(8)
  v_mfma_f32_32x32x16_bf16 v[44:59], v[220:223], v[116:119], v[44:59]
  ds_read_b64_tr_b16 v[136:137], v208 offset:54272
  ds_read_b64_tr_b16 v[138:139], v208 offset:54784
  s_waitcnt lgkmcnt(8)
  v_mfma_f32_32x32x16_bf16 v[44:59], v[220:223], v[120:123], v[44:59]
  ds_read_b64_tr_b16 v[140:141], v212 offset:0
  ds_read_b64_tr_b16 v[142:143], v212 offset:512
  s_waitcnt lgkmcnt(8)
  v_mfma_f32_32x32x16_bf16 v[44:59], v[220:223], v[124:127], v[44:59]
  ds_read_b64_tr_b16 v[144:145], v212 offset:1024
  ds_read_b64_tr_b16 v[146:147], v212 offset:1536
  s_waitcnt lgkmcnt(8)
  v_mfma_f32_32x32x16_bf16 v[44:59], v[220:223], v[128:131], v[44:59]
  ds_read_b64_tr_b16 v[148:149], v212 offset:4096
  ds_read_b64_tr_b16 v[150:151], v212 offset:4608
  s_waitcnt lgkmcnt(8)
  v_mfma_f32_32x32x16_bf16 v[44:59], v[220:223], v[132:135], v[44:59]
  ds_read_b64_tr_b16 v[152:153], v212 offset:5120
  ds_read_b64_tr_b16 v[154:155], v212 offset:5632
  s_waitcnt lgkmcnt(8)
  v_mfma_f32_32x32x16_bf16 v[44:59], v[220:223], v[136:139], v[44:59]
  ds_read_b64_tr_b16 v[156:157], v204 offset:0
  ds_read_b64_tr_b16 v[158:159], v204 offset:512
  s_waitcnt lgkmcnt(8)
  v_mfma_f32_32x32x16_bf16 v[44:59], v[220:223], v[140:143], v[44:59]
  ds_read_b64_tr_b16 v[160:161], v204 offset:1024
  ds_read_b64_tr_b16 v[162:163], v204 offset:1536
  s_waitcnt lgkmcnt(8)
  v_mfma_f32_32x32x16_bf16 v[44:59], v[220:223], v[144:147], v[44:59]
  ds_read_b64_tr_b16 v[164:165], v204 offset:4096
  ds_read_b64_tr_b16 v[166:167], v204 offset:4608
  s_waitcnt lgkmcnt(8)
  v_mfma_f32_32x32x16_bf16 v[44:59], v[220:223], v[148:151], v[44:59]
  ds_read_b64_tr_b16 v[168:169], v204 offset:5120
  ds_read_b64_tr_b16 v[170:171], v204 offset:5632
  s_waitcnt lgkmcnt(8)
  v_mfma_f32_32x32x16_bf16 v[44:59], v[220:223], v[152:155], v[44:59]
  ds_read_b64_tr_b16 v[172:173], v204 offset:16384
  ds_read_b64_tr_b16 v[174:175], v204 offset:16896
  s_waitcnt lgkmcnt(8)
  v_mfma_f32_32x32x16_bf16 v[44:59], v[220:223], v[156:159], v[44:59]
  ds_read_b64_tr_b16 v[176:177], v204 offset:17408
  ds_read_b64_tr_b16 v[178:179], v204 offset:17920
  s_waitcnt lgkmcnt(8)
  v_mfma_f32_32x32x16_bf16 v[44:59], v[220:223], v[160:163], v[44:59]
  ds_read_b64_tr_b16 v[180:181], v204 offset:20480
  ds_read_b64_tr_b16 v[182:183], v204 offset:20992
  s_waitcnt lgkmcnt(8)
  v_mfma_f32_32x32x16_bf16 v[44:59], v[220:223], v[164:167], v[44:59]
  ds_read_b64_tr_b16 v[184:185], v204 offset:21504
  ds_read_b64_tr_b16 v[186:187], v204 offset:22016
  s_waitcnt lgkmcnt(8)
  v_mfma_f32_32x32x16_bf16 v[44:59], v[220:223], v[168:171], v[44:59]
  ds_read_b64_tr_b16 v[188:189], v204 offset:32768
  ds_read_b64_tr_b16 v[190:191], v204 offset:33280
  s_waitcnt lgkmcnt(8)
  v_mfma_f32_32x32x16_bf16 v[44:59], v[220:223], v[172:175], v[44:59]
  ds_read_b64_tr_b16 v[192:193], v204 offset:33792
  ds_read_b64_tr_b16 v[194:195], v204 offset:34304
  s_waitcnt lgkmcnt(8)
  v_mfma_f32_32x32x16_bf16 v[44:59], v[220:223], v[176:179], v[44:59]
  ds_read_b64_tr_b16 v[196:197], v204 offset:36864
  ds_read_b64_tr_b16 v[198:199], v204 offset:37376
  s_waitcnt lgkmcnt(8)
  v_mfma_f32_32x32x16_bf16 v[44:59], v[220:223], v[180:183], v[44:59]
  ds_read_b64_tr_b16 v[200:201], v204 offset:37888
  ds_read_b64_tr_b16 v[202:203], v204 offset:38400
  s_waitcnt lgkmcnt(8)
  v_mfma_f32_32x32x16_bf16 v[44:59], v[220:223], v[184:187], v[44:59]
  s_waitcnt lgkmcnt(6)
  v_mfma_f32_32x32x16_bf16 v[44:59], v[220:223], v[188:191], v[44:59]
  s_waitcnt lgkmcnt(4)
  v_mfma_f32_32x32x16_bf16 v[44:59], v[220:223], v[192:195], v[44:59]
  s_waitcnt lgkmcnt(2)
  v_mfma_f32_32x32x16_bf16 v[44:59], v[220:223], v[196:199], v[44:59]
  s_waitcnt lgkmcnt(0)
  v_mfma_f32_32x32x16_bf16 v[44:59], v[220:223], v[200:203], v[44:59]
  v_mov_b32 v61, s45
  s_lshl_b32 s50, s69, 10
  s_lshl3_add_u32 s50, s40, s50
  s_add_u32 s50, s50, 196608
  s_nop 7
  v_cvt_pk_bf16_f32 v60, v44, v44
  v_lshlrev_b32_e64 v60, 16, v60
  v_sub_f32 v62, v44, v60
  v_cvt_pk_bf16_f32 v60, v60, v62
  s_cmp_ge_u32 s69, 28
  s_cbranch_scc1 Lspare_done
  s_mov_b32 exec_hi, 0
  buffer_store_dwordx2 v[60:61], v32, s[32:35], s50 offen sc1
  s_mov_b64 exec, -1
Lspare_done:
  s_and_b32 s48, s42, 1
  s_lshl1_add_u32 s48, s41, s48
  s_lshl2_add_u32 s48, s48, s40
  s_mul_i32 s48, s48, 14336
  buffer_load_dword v63, v0, s[24:27], s48 offen
  s_add_u32 s48, s48, 6144
  buffer_load_dword v64, v0, s[24:27], s48 offen
  s_barrier
  s_lshl_b32 s48, s40, 8
  s_or_b32 s48, s2, s48
  s_cmp_lg_u32 s48, 223
  s_cbranch_scc1 Lnoep
  s_mov_b32 s59, 0
  v_lshlrev_b32 v20, 5, v1
  s_mov_b32 s48, 36864
Lep:
  buffer_load_dwordx4 v[24:27], v20, s[32:35], s48 offen offset:0 sc1
  buffer_load_dwordx4 v[28:31], v20, s[32:35], s48 offen offset:16 sc1
  s_add_u32 s59, s59, 1
  s_waitcnt vmcnt(0)
  v_xor_b32 v24, s45, v24
  v_xor_b32 v26, s45, v26
  v_xor_b32 v28, s45, v28
  v_xor_b32 v30, s45, v30
  v_or3_b32 v28, v24, v26, v28
  v_or_b32 v28, v28, v30
  v_cmp_ne_u32 vcc, 0, v28
  s_nop 0
  s_cbranch_vccz Lepd
  s_cmp_lt_u32 s59, 1048576
  s_cbranch_scc1 Lep
Lepd:
  s_mov_b64 exec, 1
  v_mov_b32_e64 v20, s45
  buffer_store_dword v20, off, s[32:35], 0 offset:0 sc1
  s_mov_b64 exec, -1
Lnoep:
  s_and_b32 s48, s41, 1
  s_mul_i32 s48, s48, 917504
  s_and_b32 s49, s42, 1
  s_lshl_b32 s49, s49, 15
  s_add_u32 s48, s48, s49
  s_lshl_b32 s49, s40, 13
  s_add_u32 s48, s48, s49
  s_add_u32 m0, s64, 49152
  s_add_u32 s62, s65, 0
  buffer_load_dwordx4 v3, s[24:27], s62 offen offset:0 lds
  buffer_load_dwordx4 v4, s[24:27], s62 offen offset:1024 lds
  buffer_load_dwordx4 v5, s[24:27], s62 offen offset:2048 lds
  buffer_load_dwordx4 v6, s[24:27], s62 offen offset:3072 lds
  s_add_u32 m0, s64, 147456
  s_add_u32 s62, s65, 131072
  buffer_load_dwordx4 v3, s[24:27], s62 offen offset:0 lds
  buffer_load_dwordx4 v4, s[24:27], s62 offen offset:1024 lds
  buffer_load_dwordx4 v5, s[24:27], s62 offen offset:2048 lds
  buffer_load_dwordx4 v6, s[24:27], s62 offen offset:3072 lds
  s_add_u32 m0, s64, 65536
  s_add_u32 s62, s65, 262144
  buffer_load_dwordx4 v3, s[24:27], s62 offen offset:0 lds
  buffer_load_dwordx4 v4, s[24:27], s62 offen offset:1024 lds
  buffer_load_dwordx4 v5, s[24:27], s62 offen offset:2048 lds
  buffer_load_dwordx4 v6, s[24:27], s62 offen offset:3072 lds
  s_add_u32 m0, s64, 81920
  s_add_u32 s62, s65, 393216
  buffer_load_dwordx4 v3, s[24:27], s62 offen offset:0 lds
  buffer_load_dwordx4 v4, s[24:27], s62 offen offset:1024 lds
  buffer_load_dwordx4 v5, s[24:27], s62 offen offset:2048 lds
  buffer_load_dwordx4 v6, s[24:27], s62 offen offset:3072 lds
  s_add_u32 m0, s64, 98304
  s_add_u32 s62, s65, 524288
  buffer_load_dwordx4 v3, s[24:27], s62 offen offset:0 lds
  buffer_load_dwordx4 v4, s[24:27], s62 offen offset:1024 lds
  buffer_load_dwordx4 v5, s[24:27], s62 offen offset:2048 lds
  buffer_load_dwordx4 v6, s[24:27], s62 offen offset:3072 lds
  s_add_u32 m0, s64, 114688
  s_add_u32 s62, s65, 655360
  buffer_load_dwordx4 v3, s[24:27], s62 offen offset:0 lds
  buffer_load_dwordx4 v4, s[24:27], s62 offen offset:1024 lds
  buffer_load_dwordx4 v5, s[24:27], s62 offen offset:2048 lds
  buffer_load_dwordx4 v6, s[24:27], s62 offen offset:3072 lds
  s_add_u32 m0, s64, 131072
  s_add_u32 s62, s65, 786432
  buffer_load_dwordx4 v3, s[24:27], s62 offen offset:0 lds
  buffer_load_dwordx4 v4, s[24:27], s62 offen offset:1024 lds
  buffer_load_dwordx4 v5, s[24:27], s62 offen offset:2048 lds
  buffer_load_dwordx4 v6, s[24:27], s62 offen offset:3072 lds
  s_add_u32 m0, s64, 0
  s_nop 0
  s_add_u32 s62, s65, 65536
  buffer_load_dwordx4 v3, s[24:27], s62 offen offset:0 lds
  buffer_load_dwordx4 v4, s[24:27], s62 offen offset:1024 lds
  buffer_load_dwordx4 v5, s[24:27], s62 offen offset:2048 lds
  buffer_load_dwordx4 v6, s[24:27], s62 offen offset:3072 lds
  v_bfe_u32 v20, v1, 2, 2
  v_and_b32 v21, 1, v1
  v_lshlrev_b32 v21, 1, v21
  v_bfe_u32 v22, v1, 4, 1
  v_add_u32 v21, v21, v22
  v_lshrrev_b32 v22, 1, v20
  v_xor_b32_e64 v22, s47, v22
  v_lshl_add_u32 v21, v22, 2, v21
  v_lshlrev_b32_e64 v21, 4, v21
  v_bfe_u32 v22, v1, 1, 1
  v_lshl_add_u32 v21, v22, 3, v21
  v_lshrrev_b32_e64 v22, 5, v1
  v_lshl_add_u32 v20, v22, 2, v20
  v_lshl_add_u32 v36, v20, 7, v21
  s_lshl_b32 s50, s47, 13
  v_add_u32 v36, s50, v36
  v_xor_b32_e64 v37, 64, v36
  v_add_u32 v38, 65536, v36
  v_add_u32 v39, 65536, v37
  v_add_u32 v40, 131072, v36
  v_add_u32 v41, 131072, v37
  v_lshlrev_b32_e64 v44, 16, v12
  v_and_b32 v45, 0xffff0000, v12
  v_lshlrev_b32_e64 v46, 16, v13
  v_and_b32 v47, 0xffff0000, v13
  v_lshlrev_b32_e64 v48, 16, v14
  v_and_b32 v49, 0xffff0000, v14
  v_lshlrev_b32_e64 v50, 16, v15
  v_and_b32 v51, 0xffff0000, v15
  v_lshlrev_b32_e64 v52, 16, v16
  v_and_b32 v53, 0xffff0000, v16
  v_lshlrev_b32_e64 v54, 16, v17
  v_and_b32 v55, 0xffff0000, v17
  v_lshlrev_b32_e64 v56, 16, v18
  v_and_b32 v57, 0xffff0000, v18
  v_lshlrev_b32_e64 v58, 16, v19
  v_and_b32 v59, 0xffff0000, v19
  s_xor_b32 s50, s40, 1
  s_lshl_b32 s50, s50, 12
  s_add_u32 s50, s50, 98304
  v_add_u32 v33, s50, v2
  v_xor_b32 v34, 4096, v33
  s_lshl_b32 s50, s46, 12
  s_add_u32 s50, s50, 114688
  v_lshrrev_b32 v20, 5, v1
  s_lshl_b32 s51, s47, 1
  v_add_lshl_u32 v20, v20, s51, 1
  v_and_b32 v21, 7, v1
  v_xor_b32 v20, v20, v21
  v_and_b32 v22, 31, v1
  v_lshlrev_b32 v22, 7, v22
  v_lshl_add_u32 v20, v20, 4, v22
  v_add_u32 v42, s50, v20
  v_xor_b32 v43, 16, v42
  v_lshrrev_b32 v22, 3, v1
  v_xor_b32 v20, v21, v22
  v_lshlrev_b32_e64 v20, 4, v20
  v_lshl_add_u32 v20, v22, 7, v20
  s_lshl_b32 s51, s47, 11
  s_add_u32 s50, s50, s51
  v_add_u32 v35, s50, v20
  s_lshl_b32 s50, s68, 5
  s_add_u32 s50, s50, s47
  s_lshl3_add_u32 s50, s50, s44
  s_lshl_b32 s50, s50, 7
  v_lshlrev_b32 v21, 4, v21
  v_lshl_add_u32 v21, v22, 11, v21
  v_add_u32 v252, s50, v21
  s_movk_i32 s36, 16384
  s_add_u32 s38, s57, 81920
  buffer_load_dword v255, v254, s[32:35], s38 offen sc1
  s_mov_b32 s59, 0
  s_waitcnt vmcnt(0)
  v_cmp_ne_u32_e64 vcc, s45, v255
  s_nop 0
  s_cbranch_vccnz Lpoll24
Lpdone25:
  s_add_u32 s63, s21, 5242880
  buffer_load_dwordx4 a[128:131], v2, s[32:35], s63 offen offset:0 sc1
  buffer_load_dwordx4 a[132:135], v2, s[32:35], s63 offen offset:1024 sc1
  buffer_load_dwordx4 a[136:139], v2, s[32:35], s63 offen offset:2048 sc1
  buffer_load_dwordx4 a[140:143], v2, s[32:35], s63 offen offset:3072 sc1
  s_add_u32 s63, s21, 5251072
  buffer_load_dwordx4 a[144:147], v2, s[32:35], s63 offen offset:0 sc1
  buffer_load_dwordx4 a[148:151], v2, s[32:35], s63 offen offset:1024 sc1
  buffer_load_dwordx4 a[152:155], v2, s[32:35], s63 offen offset:2048 sc1
  buffer_load_dwordx4 a[156:159], v2, s[32:35], s63 offen offset:3072 sc1
  s_waitcnt vmcnt(0)
  s_branch Lp4
Lend:
  s_endpgm
.section .rodata,"a"
.p2align 6
.amdhsa_kernel sequential_preLN__sliding_local_dilated__glu_gated_bilinear__prompt_kernel
  .amdhsa_next_free_vgpr 512
  .amdhsa_next_free_sgpr 102
  .amdhsa_accum_offset 256
  .amdhsa_group_segment_fixed_size 0
  .amdhsa_kernarg_size 80
  .amdhsa_user_sgpr_count 2
  .amdhsa_user_sgpr_kernarg_segment_ptr 1
  .amdhsa_system_sgpr_workgroup_id_x 1
.end_amdhsa_kernel
```
